```python
import torch

def _softmax(x, axis=-1):
    return torch.softmax(x, dim=axis)

def _gelu(x):
    return torch.nn.functional.gelu(x, approximate='tanh')

def _silu(x):
    return torch.nn.functional.silu(x)

def _sigmoid(x):
    return torch.sigmoid(x)

def _layernorm(x, axis=-1, eps=1e-05):
    m = x.mean(dim=axis, keepdim=True)
    v = x.var(dim=axis, keepdim=True, unbiased=False)
    return (x - m) / torch.sqrt(v + eps)

def _scatter_add(tgt, idx, src, axis=0):
    return tgt.clone().index_add_(axis, idx, src)

def _segment_sum(src, seg, n):
    out = torch.zeros((n,) + src.shape[1:], dtype=src.dtype)
    return out.index_add_(0, seg, src)

def _pad(x, pw):
    flat = tuple((v for pair in reversed(pw) for v in pair))
    return torch.nn.functional.pad(x, flat)
kernel_name = 'adaLN_cond__spectral_fnet__glu_gated_glu__prompt'

def setup_inputs():

    _w = lambda a: (lambda t: t.to(torch.bfloat16) if t.is_floating_point() else t)(torch.as_tensor(a))

    def _A_setup():
        B, S, D = (1, 2048, 448)
        ns = torch.arange(S)[:, None] * torch.arange(S)[None, :]
        nd = torch.arange(D)[:, None] * torch.arange(D)[None, :]
        Ws_re = torch.cos(-2.0 * torch.pi * ns / S).to(float)
        Ws_im = torch.sin(-2.0 * torch.pi * ns / S).to(float)
        Wd_re = torch.cos(-2.0 * torch.pi * nd / D).to(float)
        Wd_im = torch.sin(-2.0 * torch.pi * nd / D).to(float)
        return {'x': _w((lambda *s: torch.randn(*s, dtype=torch.bfloat16) * 0.05)(B, S, D)), 'dft_seq_re': _w(Ws_re), 'dft_seq_im': _w(Ws_im), 'dft_hid_re': _w(Wd_re), 'dft_hid_im': _w(Wd_im)}
    _A_in = _A_setup()

    def _B_setup():
        B, S, D, F = (1, 2048, 448, 1792)
        return {'x': _w((lambda *s: torch.randn(*s, dtype=torch.bfloat16) * 0.05)(B, S, D)), 'w_gate': _w((lambda *s: torch.randn(*s, dtype=torch.bfloat16) * 3.2)(D, F)), 'w_up': _w((lambda *s: torch.randn(*s, dtype=torch.bfloat16) * 1.6)(D, F)), 'w_down': _w((lambda *s: torch.randn(*s, dtype=torch.bfloat16) * 1.6)(F, D))}
    _B_in = _B_setup()
    return {'A_x': _A_in['x'], 'A_dft_seq_re': _A_in['dft_seq_re'], 'A_dft_seq_im': _A_in['dft_seq_im'], 'A_dft_hid_re': _A_in['dft_hid_re'], 'A_dft_hid_im': _A_in['dft_hid_im'], 'B_x': _B_in['x'], 'B_w_gate': _B_in['w_gate'], 'B_w_up': _B_in['w_up'], 'B_w_down': _B_in['w_down'], 'c': _w((lambda *s: torch.randn(*s, dtype=torch.bfloat16) * 0.1)(1, 448) * 8.0), 'w_mod': _w((lambda *s: torch.randn(*s, dtype=torch.bfloat16) * 0.1)(448, 6 * 448) * 448 ** (-0.5) * 8.0)}

def reference(A_x, A_dft_seq_re, A_dft_seq_im, A_dft_hid_re, A_dft_hid_im, B_x, B_w_gate, B_w_up, B_w_down, c, w_mod):

    def _A_ref(x, dft_seq_re, dft_seq_im, dft_hid_re, dft_hid_im):
        a = torch.einsum('bsd,ed->bse', x, dft_hid_re)
        b = torch.einsum('bsd,ed->bse', x, dft_hid_im)
        y = torch.einsum('ts,bse->bte', dft_seq_re, a) - torch.einsum('ts,bse->bte', dft_seq_im, b)
        return y

    def _B_ref(x, w_gate, w_up, w_down):
        g = torch.einsum('bsd,df->bsf', x, w_gate)
        u = torch.einsum('bsd,df->bsf', x, w_up)
        h = _sigmoid(g) * u
        return torch.einsum('bsf,fd->bsd', h, w_down)
    x = A_x
    mod = (_silu(c) @ w_mod).reshape(c.shape[0], 6, 1, -1)
    sa, ca, ga, sb, cb, gb = (mod[:, 0].clone(), mod[:, 1].clone(), mod[:, 2].clone(), mod[:, 3].clone(), mod[:, 4].clone(), mod[:, 5].clone())
    h = _layernorm(x, axis=-1) * (1 + ca) + sa
    x = x + ga * _A_ref(h, A_dft_seq_re, A_dft_seq_im, A_dft_hid_re, A_dft_hid_im)
    h = _layernorm(x, axis=-1) * (1 + cb) + sb
    x = x + gb * _B_ref(h, B_w_gate, B_w_up, B_w_down)
    return x
```

```asm
; @launch grid=(256,1,1) block=(256,1,1) lds=163840
.amdgcn_target "amdgcn-amd-amdhsa--gfx950"
.text
.globl adaLN_cond__spectral_fnet__glu_gated_glu__prompt_kernel
.p2align 12
.p2align 8
.type adaLN_cond__spectral_fnet__glu_gated_glu__prompt_kernel,@function
adaLN_cond__spectral_fnet__glu_gated_glu__prompt_kernel:
KP_BASE:
    s_load_dwordx2 s[4:5], s[0:1], 0
    s_load_dwordx16 s[16:31], s[0:1], 48
    s_getpc_b64 s[6:7]
KP_PC:
    s_lshr_b32 s33, s2, 3
    v_and_b32 v1, 15, v0
    v_lshl_add_u32 v1, s33, 4, v1
    v_lshlrev_b32 v1, 7, v1
    v_min_u32 v1, KP_LAST-KP_PC-4, v1
    global_load_dword a255, v1, s[6:7]
    s_andn2_b32 s32, s2, 24
    s_cmp_lt_u32 s32, 7
    s_cbranch_scc1 KP_SIDE
    s_cmp_eq_u32 s32, 7
    s_cbranch_scc1 SD_Z
    s_cmp_ge_u32 s2, 256
    s_cbranch_scc1 KP_END
    v_lshrrev_b32 v1, 6, v0
    v_and_b32 v2, 63, v0
    v_readfirstlane_b32 s3, v1
    v_lshlrev_b32 v3, 4, v2
    v_and_b32 v4, 31, v2
    v_lshrrev_b32 v5, 5, v2
    s_mov_b32 s14, 15302656
    s_mov_b32 s15, 0x20000
    s_and_b32 s34, s2, 1
    s_lshr_b32 s35, s2, 3
    s_sub_u32 s35, s35, 4
    s_mul_i32 s33, s35, 37
    s_lshr_b32 s33, s33, 8
    s_and_b32 s6, s2, 7
    s_lshl_b32 s6, s6, 1
    s_lshr_b32 s7, s33, 1
    s_add_u32 s6, s6, s7
    s_sub_u32 s7, 32, s6
    s_cmp_eq_u32 s6, 0
    s_cselect_b32 s7, 16, s7
    s_bitcmp1_b32 s33, 0
    s_cselect_b32 s36, s7, s6
    s_and_b32 s32, s2, 6
    s_lshl_b32 s32, s32, 1
    s_add_u32 s32, s32, s33
    s_mul_i32 s33, s33, 7
    s_sub_u32 s35, s35, s33
    s_mul_i32 s33, s34, 7
    s_add_u32 s33, s33, s35
    v_lshrrev_b32 v6, 3, v2
    s_lshl_b32 s6, s3, 4
    v_add_u32 v6, s6, v6
    v_and_b32 v7, 7, v2
    v_mul_u32_u24 v246, 28672, v6
    v_lshl_add_u32 v246, v7, 4, v246
    v_add_u32 v247, 229376, v246
    s_mul_i32 s39, s36, 896
    s_lshl_b32 s40, s35, 7
    s_mov_b32 s10, 1835008
    s_mov_b32 s11, 0x20000
    s_add_u32 s37, s39, s40
    s_add_u32 s38, s39, 896
    s_and_b32 s6, s2, 7
    s_mul_i32 s7, s3, 7
    s_add_u32 s7, s7, s6
    s_add_u32 s7, s7, 14
    s_lshl_b32 s43, s3, 1
    s_add_u32 s43, s43, 1
    s_cmp_eq_u32 s6, 7
    s_cselect_b32 s7, s43, s7
    s_lshl_b32 s7, s7, 7
    s_lshr_b32 s6, s2, 3
    s_sub_u32 s6, s6, 4
    s_mul_i32 s6, s6, 86016
    s_add_u32 s7, s7, s6
    v_mul_u32_u24 v250, 5376, v2
    s_and_b32 s43, s2, 7
    s_add_u32 s43, s43, 7
    s_lshl_b32 s43, s43, 7
    s_add_u32 s43, s43, s6
    s_mul_i32 s6, s3, 21504
    s_add_u32 s43, s43, s6
    v_add_u32 v249, s43, v250
    v_add_u32 v250, s7, v250
    s_lshr_b32 s7, s3, 1
    s_mul_i32 s7, s7, 1792
    v_lshl_add_u32 v252, v2, 7, s7
    s_sub_u32 s6, s2, 32
    s_add_u32 s7, s6, 224
    s_cmp_eq_u32 s6, 128
    s_cselect_b32 s7, 224, s7
    s_cmp_lt_u32 s6, 128
    s_cselect_b32 s7, s6, s7
    s_mul_i32 s7, s7, 3584
    v_add_u32 v251, s7, v252
    s_cmp_ge_u32 s6, 96
    s_addc_u32 s6, s6, 128
    s_mul_i32 s6, s6, 3584
    v_add_u32 v252, s6, v252
    v_lshrrev_b32 v96, 4, v2
    v_bfe_u32 v97, v2, 2, 2
    v_xor_b32 v97, v97, v96
    s_waitcnt lgkmcnt(0)
    s_mov_b32 s8, s4
    s_and_b32 s9, s5, 0xffff
    s_mov_b64 exec, 15
    global_load_dword a251, v249, s[24:25]
    s_mov_b64 exec, -1
    buffer_load_dwordx4 v[16:19], v246, s[8:11], s37 offen
    buffer_load_dwordx4 v[44:47], v247, s[8:11], s37 offen
    s_mov_b64 s[0:1], s[24:25]
    s_mov_b64 s[80:81], s[26:27]
    s_bitcmp1_b32 s3, 0
    s_cselect_b64 s[26:27], s[18:19], s[16:17]
    s_mov_b64 s[82:83], s[20:21]
    s_mov_b32 s12, s30
    s_and_b32 s13, s31, 0xffff
    s_sub_u32 s20, s18, 1024
    s_subb_u32 s21, s19, 0
    s_and_b32 s21, s21, 0xffff
    s_mov_b32 s22, 1606656
    s_mov_b32 s23, 0x20000
    s_and_b32 s17, s17, 0xffff
    s_mov_b32 s18, 1605632
    s_mov_b32 s19, 0x20000
    v_and_b32 v98, 3, v2
    v_lshlrev_b32 v98, 4, v98
    v_lshl_add_u32 v97, v97, 6, v98
    s_lshl_b32 s6, s33, 8
    v_add_u32 v97, s6, v97
    s_add_u32 s37, s37, 128
    s_cmp_ge_u32 s37, s38
    s_cselect_b32 s37, s39, s37
    buffer_load_dwordx4 v[20:23], v246, s[8:11], s37 offen
    s_lshl_b32 s6, s3, 2
    v_add_u32 v96, s6, v96
    v_mul_u32_u24 v208, 3584, v96
    v_sub_u32 v209, 53760, v208
    v_add_u32 v208, v208, v97
    v_add_u32 v209, v209, v97
    v_cmp_eq_u32 vcc, 0, v96
    v_mov_b32 v97, 1551872
    v_mov_b32 v98, 749056
    v_cndmask_b32 v97, v97, v98, vcc
    v_add_u32 v210, v209, v97
    s_lshl_b32 s60, s3, 11
    s_and_b32 s46, s3, 1
    s_lshl_b32 s46, s46, 4
    s_lshr_b32 s47, s3, 1
    v_and_b32 v11, 15, v2
    buffer_load_dwordx4 v[48:51], v247, s[8:11], s37 offen
    v_add_u32 v12, s46, v11
    v_cvt_f32_u32 v13, v12
    s_cmp_eq_u32 s47, 1
    s_cselect_b32 s6, 0x3e800000, 0
    s_cselect_b32 s7, 0x42000000, 0
    v_cmp_eq_u32 vcc, 0, v12
    v_mov_b32 v96, s6
    v_mov_b32 v97, s7
    v_cndmask_b32 v13, v13, v97, vcc
    v_cndmask_b32 v96, v96, 0, vcc
    v_mul_f32 v13, 0x3c800000, v13
    v_lshrrev_b32 v14, 4, v2
    v_lshlrev_b32 v14, 2, v14
    v_cvt_f32_u32 v97, v14
    v_fma_f32 v96, v13, v97, v96
    v_fmamk_f32 v98, v13, 0x00000000, v96
    s_add_u32 s37, s37, 128
    s_cmp_ge_u32 s37, s38
    s_cselect_b32 s37, s39, s37
    buffer_load_dwordx4 v[24:27], v246, s[8:11], s37 offen
    v_fmamk_f32 v99, v13, 0x3f800000, v96
    v_fmamk_f32 v100, v13, 0x40000000, v96
    v_fmamk_f32 v101, v13, 0x40400000, v96
    v_fmamk_f32 v102, v13, 0x41800000, v96
    v_fmamk_f32 v103, v13, 0x41880000, v96
    v_fmamk_f32 v104, v13, 0x41900000, v96
    v_fmamk_f32 v105, v13, 0x41980000, v96
    v_cos_f32 v98, v98
    v_cos_f32 v99, v99
    v_cos_f32 v100, v100
    v_cos_f32 v101, v101
    v_cos_f32 v102, v102
    buffer_load_dwordx4 v[52:55], v247, s[8:11], s37 offen
    v_cos_f32 v103, v103
    v_cos_f32 v104, v104
    v_cos_f32 v105, v105
    v_cvt_pk_bf16_f32 v88, v98, v99
    v_cvt_pk_bf16_f32 v89, v100, v101
    v_cvt_pk_bf16_f32 v90, v102, v103
    v_cvt_pk_bf16_f32 v91, v104, v105
    v_fmamk_f32 v98, v13, 0x42000000, v96
    v_fmamk_f32 v99, v13, 0x42040000, v96
    v_fmamk_f32 v100, v13, 0x42080000, v96
    v_fmamk_f32 v101, v13, 0x420c0000, v96
    v_fmamk_f32 v102, v13, 0x42400000, v96
    s_add_u32 s37, s37, 128
    s_cmp_ge_u32 s37, s38
    s_cselect_b32 s37, s39, s37
    buffer_load_dwordx4 v[28:31], v246, s[8:11], s37 offen
    v_fmamk_f32 v103, v13, 0x42440000, v96
    v_fmamk_f32 v104, v13, 0x42480000, v96
    v_fmamk_f32 v105, v13, 0x424c0000, v96
    v_cos_f32 v98, v98
    v_cos_f32 v99, v99
    v_cos_f32 v100, v100
    v_cos_f32 v101, v101
    v_cos_f32 v102, v102
    v_cos_f32 v103, v103
    v_cos_f32 v104, v104
    buffer_load_dwordx4 v[56:59], v247, s[8:11], s37 offen
    v_cos_f32 v105, v105
    v_cvt_pk_bf16_f32 v92, v98, v99
    v_cvt_pk_bf16_f32 v93, v100, v101
    v_cvt_pk_bf16_f32 v94, v102, v103
    v_cvt_pk_bf16_f32 v95, v104, v105
    v_mul_u32_u24 v6, 160, v6
    v_lshl_add_u32 v244, v7, 4, v6
    v_lshrrev_b32 v7, 2, v2
    v_mul_u32_u24 v7, 160, v7
    v_and_b32 v12, 3, v2
    v_lshl_add_u32 v245, v12, 3, v7
    v_add_u32 v14, s46, v14
    v_mul_u32_u24 v14, 57344, v14
    v_lshl_add_u32 v248, v11, 3, v14
    s_add_u32 s37, s37, 128
    s_cmp_ge_u32 s37, s38
    s_cselect_b32 s37, s39, s37
    buffer_load_dwordx4 v[32:35], v246, s[8:11], s37 offen
    s_mul_i32 s47, s47, 28672
    s_add_u32 s47, s47, s39
    s_add_u32 s47, s47, s40
    s_mov_b32 s73, 0x3f803f80
    v_mov_b64 v[96:97], 0
    v_mov_b64 v[98:99], 0
    v_mov_b64 v[100:101], 0
    v_mov_b64 v[102:103], 0
    v_mov_b32 v233, 0x3727c5ac
    s_sub_u32 s6, s2, 32
    s_mul_i32 s7, s6, 9363
    s_lshr_b32 s7, s7, 16
    s_mul_i32 s64, s7, 7
    s_sub_u32 s64, s6, s64
    s_lshl_b32 s7, s7, 2
    s_add_u32 s7, s7, s3
    buffer_load_dwordx4 v[60:63], v247, s[8:11], s37 offen
    s_min_u32 s65, s7, 111
    s_mul_i32 s65, s65, 14336
    s_lshl_b32 s67, s64, 7
    s_add_u32 s65, s65, s67
    v_mul_u32_u24 v224, 3584, v5
    v_and_b32 v232, 15, v2
    v_bfe_u32 v225, v2, 4, 1
    v_lshlrev_b32 v234, 3, v232
    v_lshl_add_u32 v234, v225, 2, v234
    v_add_u32 v224, v234, v224
    v_lshl_add_u32 v234, v5, 7, v234
    v_lshlrev_b32 v232, 4, v232
    v_lshl_add_u32 v232, v5, 8, v232
    v_lshl_add_u32 v232, v225, 11, v232
    v_add_u32 v224, s65, v224
    v_add_u32 v225, 7168, v224
    s_lshl_b32 s64, s64, 2
    s_bfe_u32 s65, s7, 0x20001
    s_add_u32 s64, s64, s65
    s_mul_i32 s64, s64, 14
    s_lshr_b32 s65, s7, 3
    s_add_u32 s64, s64, s65
    s_lshl_b32 s64, s64, 3
    s_and_b32 s65, s7, 1
    s_add_u32 s64, s64, s65
    s_lshl_b32 s64, s64, 9
    s_add_u32 s64, s64, 2686976
    s_lshl_b32 s65, s32, 9
    s_sub_u32 s67, s67, s65
    s_add_u32 s67, s67, 18432
    s_cmp_lt_u32 s6, 196
    s_cselect_b32 s64, s64, 0x7fff0000
    s_cselect_b32 s69, s3, 0
    s_mov_b32 s65, 0x05040100
    s_mov_b32 s66, 0x07060302
    s_mul_i32 s6, s3, 4096
    s_add_u32 s40, s40, s6
    s_lshl_b32 s6, s32, 9
    s_sub_u32 s40, s40, s6
    s_add_u32 s40, s40, 20480
    v_bfe_u32 v211, v2, 2, 2
    v_xor_b32 v192, s3, v211
    v_lshlrev_b32 v211, 8, v211
    v_lshl_add_u32 v211, v192, 6, v211
    v_bfe_u32 v192, v2, 4, 1
    v_lshl_add_u32 v211, v192, 5, v211
    v_and_b32 v192, 3, v2
    v_lshl_add_u32 v211, v192, 3, v211
    v_lshl_add_u32 v211, v5, 11, v211
    v_add_u32 v211, 65536, v211
    v_add_u32 v212, 0x10000, v211
    s_and_b32 s48, s3, 1
    s_lshr_b32 s49, s3, 1
    v_lshrrev_b32 v6, 3, v2
    s_lshl_b32 s6, s3, 4
    v_add_u32 v6, s6, v6
    v_mul_u32_u24 v6, 896, v6
    v_lshrrev_b32 v200, 4, v2
    v_xor_b32 v200, v200, v2
    v_and_b32 v200, 7, v200
    v_xor_b32 v201, 4, v200
    v_lshl_add_u32 v201, v201, 4, v6
    v_add_u32 v201, 6144, v201
    v_lshl_add_u32 v200, v200, 4, v6
    s_mul_i32 s52, s36, 57344
    s_mul_i32 s54, s49, 28
    s_lshl_b32 s55, s48, 1
    s_add_u32 s54, s54, s55
    s_lshl_b32 s54, s54, 10
    s_mul_i32 s55, s35, 57344
    s_add_u32 s55, s55, s54
    s_add_u32 s55, s55, 1835008
    s_mov_b32 s70, s52
    s_mov_b32 s71, s55
    s_add_u32 s72, s52, 896
    s_and_b32 s6, s2, 0
    s_min_u32 s6, s6, 6
    s_lshl_b32 s6, s6, 7
    s_cmp_eq_u32 s3, 1
    s_cbranch_scc1 PT_2
    s_cmp_eq_u32 s3, 2
    s_cbranch_scc1 PT_3
    s_cmp_eq_u32 s3, 3
    s_cbranch_scc1 PT_4
    s_branch PL_1
PE_1:
    .p2align 12
PT_1:
PL_1:
    s_waitcnt vmcnt(9)
    s_add_u32 s37, s37, 128
    s_cmp_ge_u32 s37, s38
    s_cselect_b32 s37, s39, s37
    buffer_load_dwordx4 v[36:39], v246, s[8:11], s37 offen
    v_dot2_f32_bf16 v96, v16, s73, v96
    v_dot2_f32_bf16 v98, v16, v16, v98
    v_dot2_f32_bf16 v97, v17, s73, v97
    v_dot2_f32_bf16 v99, v17, v17, v99
    v_dot2_f32_bf16 v96, v18, s73, v96
    v_dot2_f32_bf16 v98, v18, v18, v98
    v_dot2_f32_bf16 v97, v19, s73, v97
    v_dot2_f32_bf16 v99, v19, v19, v99
    v_lshlrev_b32 v72, 16, v16
    v_and_b32 v73, 0xffff0000, v16
    v_lshlrev_b32 v74, 16, v17
    v_and_b32 v75, 0xffff0000, v17
    v_lshlrev_b32 v76, 16, v18
    v_and_b32 v77, 0xffff0000, v18
    v_lshlrev_b32 v78, 16, v19
    v_and_b32 v79, 0xffff0000, v19
    s_waitcnt vmcnt(9)
    buffer_load_dwordx4 v[64:67], v247, s[8:11], s37 offen
    v_dot2_f32_bf16 v100, v44, s73, v100
    v_dot2_f32_bf16 v102, v44, v44, v102
    v_dot2_f32_bf16 v101, v45, s73, v101
    v_dot2_f32_bf16 v103, v45, v45, v103
    v_dot2_f32_bf16 v100, v46, s73, v100
    v_dot2_f32_bf16 v102, v46, v46, v102
    v_dot2_f32_bf16 v101, v47, s73, v101
    v_dot2_f32_bf16 v103, v47, v47, v103
    v_lshlrev_b32 v80, 16, v44
    v_and_b32 v81, 0xffff0000, v44
    v_lshlrev_b32 v82, 16, v45
    v_and_b32 v83, 0xffff0000, v45
    v_lshlrev_b32 v84, 16, v46
    v_and_b32 v85, 0xffff0000, v46
    v_lshlrev_b32 v86, 16, v47
    v_and_b32 v87, 0xffff0000, v47
    s_waitcnt vmcnt(9)
    s_add_u32 s37, s37, 128
    s_cmp_ge_u32 s37, s38
    s_cselect_b32 s37, s39, s37
    buffer_load_dwordx4 v[40:43], v246, s[8:11], s37 offen
    v_dot2_f32_bf16 v96, v20, s73, v96
    v_dot2_f32_bf16 v98, v20, v20, v98
    v_dot2_f32_bf16 v97, v21, s73, v97
    v_dot2_f32_bf16 v99, v21, v21, v99
    v_dot2_f32_bf16 v96, v22, s73, v96
    v_dot2_f32_bf16 v98, v22, v22, v98
    v_dot2_f32_bf16 v97, v23, s73, v97
    v_dot2_f32_bf16 v99, v23, v23, v99
    s_waitcnt vmcnt(9)
    buffer_load_dwordx4 v[68:71], v247, s[8:11], s37 offen
    v_dot2_f32_bf16 v100, v48, s73, v100
    v_dot2_f32_bf16 v102, v48, v48, v102
    v_dot2_f32_bf16 v101, v49, s73, v101
    v_dot2_f32_bf16 v103, v49, v49, v103
    v_dot2_f32_bf16 v100, v50, s73, v100
    v_dot2_f32_bf16 v102, v50, v50, v102
    v_dot2_f32_bf16 v101, v51, s73, v101
    v_dot2_f32_bf16 v103, v51, v51, v103
    s_waitcnt vmcnt(9)
    v_dot2_f32_bf16 v96, v24, s73, v96
    v_dot2_f32_bf16 v98, v24, v24, v98
    v_dot2_f32_bf16 v97, v25, s73, v97
    v_dot2_f32_bf16 v99, v25, v25, v99
    v_dot2_f32_bf16 v96, v26, s73, v96
    v_dot2_f32_bf16 v98, v26, v26, v98
    v_dot2_f32_bf16 v97, v27, s73, v97
    v_dot2_f32_bf16 v99, v27, v27, v99
    s_waitcnt vmcnt(8)
    v_dot2_f32_bf16 v100, v52, s73, v100
    v_dot2_f32_bf16 v102, v52, v52, v102
    v_dot2_f32_bf16 v101, v53, s73, v101
    v_dot2_f32_bf16 v103, v53, v53, v103
    v_dot2_f32_bf16 v100, v54, s73, v100
    v_dot2_f32_bf16 v102, v54, v54, v102
    v_dot2_f32_bf16 v101, v55, s73, v101
    v_dot2_f32_bf16 v103, v55, v55, v103
    s_waitcnt vmcnt(7)
    s_barrier
    s_mov_b64 exec, 0xffff
    global_load_dword a254, v250, s[0:1]
    s_mov_b64 exec, -1
    v_dot2_f32_bf16 v96, v28, s73, v96
    v_dot2_f32_bf16 v98, v28, v28, v98
    v_dot2_f32_bf16 v97, v29, s73, v97
    v_dot2_f32_bf16 v99, v29, v29, v99
    v_dot2_f32_bf16 v96, v30, s73, v96
    v_dot2_f32_bf16 v98, v30, v30, v98
    v_dot2_f32_bf16 v97, v31, s73, v97
    v_dot2_f32_bf16 v99, v31, v31, v99
    s_waitcnt vmcnt(7)
    s_mov_b64 exec, 0x3fff
    global_load_dword a253, v251, s[26:27]
    s_mov_b64 exec, -1
    v_dot2_f32_bf16 v100, v56, s73, v100
    v_dot2_f32_bf16 v102, v56, v56, v102
    v_dot2_f32_bf16 v101, v57, s73, v101
    v_dot2_f32_bf16 v103, v57, v57, v103
    v_dot2_f32_bf16 v100, v58, s73, v100
    v_dot2_f32_bf16 v102, v58, v58, v102
    v_dot2_f32_bf16 v101, v59, s73, v101
    v_dot2_f32_bf16 v103, v59, v59, v103
    s_waitcnt vmcnt(7)
    s_add_u32 m0, s60, 65536
    s_nop 0
    buffer_load_dwordx4 v208, s[16:19], 0 offen lds
    v_dot2_f32_bf16 v96, v32, s73, v96
    v_dot2_f32_bf16 v98, v32, v32, v98
    v_dot2_f32_bf16 v97, v33, s73, v97
    v_dot2_f32_bf16 v99, v33, v33, v99
    v_dot2_f32_bf16 v96, v34, s73, v96
    v_dot2_f32_bf16 v98, v34, v34, v98
    v_dot2_f32_bf16 v97, v35, s73, v97
    v_dot2_f32_bf16 v99, v35, v35, v99
    s_waitcnt vmcnt(7)
    buffer_load_dwordx4 v208, s[20:23], 0 offen offset:1024 lds
    v_dot2_f32_bf16 v100, v60, s73, v100
    v_dot2_f32_bf16 v102, v60, v60, v102
    v_dot2_f32_bf16 v101, v61, s73, v101
    v_dot2_f32_bf16 v103, v61, v61, v103
    v_dot2_f32_bf16 v100, v62, s73, v100
    v_dot2_f32_bf16 v102, v62, v62, v102
    v_dot2_f32_bf16 v101, v63, s73, v101
    v_dot2_f32_bf16 v103, v63, v63, v103
    s_waitcnt vmcnt(7)
    v_dot2_f32_bf16 v96, v36, s73, v96
    v_dot2_f32_bf16 v98, v36, v36, v98
    v_dot2_f32_bf16 v97, v37, s73, v97
    v_dot2_f32_bf16 v99, v37, v37, v99
    v_dot2_f32_bf16 v96, v38, s73, v96
    v_dot2_f32_bf16 v98, v38, v38, v98
    v_dot2_f32_bf16 v97, v39, s73, v97
    v_dot2_f32_bf16 v99, v39, v39, v99
    s_waitcnt vmcnt(6)
    v_dot2_f32_bf16 v100, v64, s73, v100
    v_dot2_f32_bf16 v102, v64, v64, v102
    v_dot2_f32_bf16 v101, v65, s73, v101
    v_dot2_f32_bf16 v103, v65, v65, v103
    v_dot2_f32_bf16 v100, v66, s73, v100
    v_dot2_f32_bf16 v102, v66, v66, v102
    v_dot2_f32_bf16 v101, v67, s73, v101
    v_dot2_f32_bf16 v103, v67, v67, v103
    s_waitcnt vmcnt(5)
    v_dot2_f32_bf16 v96, v40, s73, v96
    v_dot2_f32_bf16 v98, v40, v40, v98
    v_dot2_f32_bf16 v97, v41, s73, v97
    v_dot2_f32_bf16 v99, v41, v41, v99
    v_dot2_f32_bf16 v96, v42, s73, v96
    v_dot2_f32_bf16 v98, v42, v42, v98
    v_dot2_f32_bf16 v97, v43, s73, v97
    v_dot2_f32_bf16 v99, v43, v43, v99
    s_waitcnt vmcnt(4)
    v_dot2_f32_bf16 v100, v68, s73, v100
    v_dot2_f32_bf16 v102, v68, v68, v102
    v_dot2_f32_bf16 v101, v69, s73, v101
    v_dot2_f32_bf16 v103, v69, v69, v103
    v_dot2_f32_bf16 v100, v70, s73, v100
    v_dot2_f32_bf16 v102, v70, v70, v102
    v_dot2_f32_bf16 v101, v71, s73, v101
    v_dot2_f32_bf16 v103, v71, v71, v103
    v_add_f32 v96, v96, v97
    v_add_f32 v98, v98, v99
    v_add_f32 v100, v100, v101
    v_add_f32 v102, v102, v103
    v_add_f32_dpp v96, v96, v96 quad_perm:[1,0,3,2] row_mask:0xf bank_mask:0xf
    v_add_f32_dpp v98, v98, v98 quad_perm:[1,0,3,2] row_mask:0xf bank_mask:0xf
    v_add_f32_dpp v100, v100, v100 quad_perm:[1,0,3,2] row_mask:0xf bank_mask:0xf
    v_add_f32_dpp v102, v102, v102 quad_perm:[1,0,3,2] row_mask:0xf bank_mask:0xf
    v_add_f32_dpp v96, v96, v96 quad_perm:[2,3,0,1] row_mask:0xf bank_mask:0xf
    v_add_f32_dpp v98, v98, v98 quad_perm:[2,3,0,1] row_mask:0xf bank_mask:0xf
    v_add_f32_dpp v100, v100, v100 quad_perm:[2,3,0,1] row_mask:0xf bank_mask:0xf
    v_add_f32_dpp v102, v102, v102 quad_perm:[2,3,0,1] row_mask:0xf bank_mask:0xf
    v_add_f32_dpp v96, v96, v96 row_half_mirror row_mask:0xf bank_mask:0xf
    v_add_f32_dpp v98, v98, v98 row_half_mirror row_mask:0xf bank_mask:0xf
    v_add_f32_dpp v100, v100, v100 row_half_mirror row_mask:0xf bank_mask:0xf
    v_add_f32_dpp v102, v102, v102 row_half_mirror row_mask:0xf bank_mask:0xf
    v_mul_f32 v96, 0xbb124925, v96
    v_mul_f32 v100, 0xbb124925, v100
    v_fmamk_f32 v98, v98, 0x3b124925, v233
    v_fmamk_f32 v102, v102, 0x3b124925, v233
    v_fma_f32 v98, -v96, v96, v98
    v_fma_f32 v102, -v100, v100, v102
    v_max_f32 v98, v233, v98
    v_max_f32 v102, v233, v102
    v_rsq_f32 v98, v98
    v_rsq_f32 v102, v102
    v_mul_f32 v96, v96, v98
    v_mul_f32 v100, v100, v102
    v_pk_fma_f32 v[72:73], v[72:73], v[98:99], v[96:97] op_sel_hi:[1,0,0]
    v_pk_fma_f32 v[74:75], v[74:75], v[98:99], v[96:97] op_sel_hi:[1,0,0]
    v_pk_fma_f32 v[76:77], v[76:77], v[98:99], v[96:97] op_sel_hi:[1,0,0]
    v_pk_fma_f32 v[78:79], v[78:79], v[98:99], v[96:97] op_sel_hi:[1,0,0]
    v_cvt_pk_bf16_f32 v16, v72, v73
    v_cvt_pk_bf16_f32 v17, v74, v75
    v_cvt_pk_bf16_f32 v18, v76, v77
    v_cvt_pk_bf16_f32 v19, v78, v79
    ds_write_b128 v244, v[16:19] offset:0
    v_pk_fma_f32 v[80:81], v[80:81], v[102:103], v[100:101] op_sel_hi:[1,0,0]
    v_pk_fma_f32 v[82:83], v[82:83], v[102:103], v[100:101] op_sel_hi:[1,0,0]
    v_pk_fma_f32 v[84:85], v[84:85], v[102:103], v[100:101] op_sel_hi:[1,0,0]
    v_pk_fma_f32 v[86:87], v[86:87], v[102:103], v[100:101] op_sel_hi:[1,0,0]
    v_cvt_pk_bf16_f32 v20, v80, v81
    v_cvt_pk_bf16_f32 v21, v82, v83
    v_cvt_pk_bf16_f32 v22, v84, v85
    v_cvt_pk_bf16_f32 v23, v86, v87
    ds_write_b128 v244, v[20:23] offset:1280
    s_waitcnt lgkmcnt(0)
    s_barrier
    ds_read_b64_tr_b16 v[40:41], v245 offset:0
    ds_read_b64_tr_b16 v[42:43], v245 offset:2560
    ds_read_b64_tr_b16 v[44:45], v245 offset:32
    ds_read_b64_tr_b16 v[46:47], v245 offset:2592
    ds_read_b64_tr_b16 v[48:49], v245 offset:64
    ds_read_b64_tr_b16 v[50:51], v245 offset:2624
    ds_read_b64_tr_b16 v[52:53], v245 offset:96
    ds_read_b64_tr_b16 v[54:55], v245 offset:2656
    ds_read_b64_tr_b16 v[56:57], v245 offset:5120
    ds_read_b64_tr_b16 v[58:59], v245 offset:7680
    ds_read_b64_tr_b16 v[60:61], v245 offset:5152
    ds_read_b64_tr_b16 v[62:63], v245 offset:7712
    ds_read_b64_tr_b16 v[64:65], v245 offset:5184
    ds_read_b64_tr_b16 v[66:67], v245 offset:7744
    ds_read_b64_tr_b16 v[68:69], v245 offset:5216
    ds_read_b64_tr_b16 v[70:71], v245 offset:7776
    s_waitcnt lgkmcnt(14)
    v_mfma_f32_16x16x32_bf16 v[160:163], v[88:91], v[40:43], 0
    s_waitcnt lgkmcnt(12)
    v_mfma_f32_16x16x32_bf16 v[164:167], v[88:91], v[44:47], 0
    s_waitcnt lgkmcnt(10)
    v_mfma_f32_16x16x32_bf16 v[168:171], v[88:91], v[48:51], 0
    s_waitcnt lgkmcnt(8)
    v_mfma_f32_16x16x32_bf16 v[172:175], v[88:91], v[52:55], 0
    s_waitcnt lgkmcnt(6)
    v_mfma_f32_16x16x32_bf16 v[160:163], v[92:95], v[56:59], v[160:163]
    s_waitcnt lgkmcnt(4)
    v_mfma_f32_16x16x32_bf16 v[164:167], v[92:95], v[60:63], v[164:167]
    s_waitcnt lgkmcnt(2)
    v_mfma_f32_16x16x32_bf16 v[168:171], v[92:95], v[64:67], v[168:171]
    s_waitcnt lgkmcnt(0)
    v_mfma_f32_16x16x32_bf16 v[172:175], v[92:95], v[68:71], v[172:175]
    s_nop 3
    v_cvt_pk_bf16_f32 v16, v160, v164
    s_nop 2
    v_cvt_pk_bf16_f32 v17, v168, v172
    buffer_store_dwordx2 v[16:17], v248, s[12:15], s47 offen sc1
    s_add_u32 s47, s47, 57344
    v_cvt_pk_bf16_f32 v18, v161, v165
    v_cvt_pk_bf16_f32 v19, v169, v173
    buffer_store_dwordx2 v[18:19], v248, s[12:15], s47 offen sc1
    s_add_u32 s47, s47, 57344
    v_cvt_pk_bf16_f32 v20, v162, v166
    v_cvt_pk_bf16_f32 v21, v170, v174
    buffer_store_dwordx2 v[20:21], v248, s[12:15], s47 offen sc1
    s_add_u32 s47, s47, 57344
    v_cvt_pk_bf16_f32 v22, v163, v167
    v_cvt_pk_bf16_f32 v23, v171, v175
    buffer_store_dwordx2 v[22:23], v248, s[12:15], s47 offen sc1
    s_add_u32 s52, s52, s6
    s_lshl_b32 s6, s6, 5
    s_add_u32 s55, s55, s6
    s_lshl_b32 s24, s32, 9
    s_add_u32 s24, s24, 2260992
    s_add_u32 s24, s24, s30
    s_addc_u32 s25, s31, 0
    s_lshl_b32 s6, s34, 13
    s_add_u32 s30, s24, s6
    s_addc_u32 s31, s25, 0
    s_mov_b64 s[76:77], 0
    s_mov_b32 s78, 0
    s_xor_b32 s79, s34, 1
    s_lshl_b32 s79, s79, 13
    s_mov_b32 s74, 1
    s_lshr_b32 s53, s32, 0
    s_lshl_b32 s53, s53, 10
    s_lshl_b32 s6, s32, 9
    s_sub_u32 s53, s53, s6
    s_lshl_b32 s6, s3, 8
    s_add_u32 s53, s53, s6
    s_add_u32 s53, s53, 20480
    s_add_u32 s56, s53, 128
    s_and_b32 s6, s32, 1
    s_lshl_b32 s6, s6, 10
    s_sub_u32 s68, s56, s6
    s_sub_u32 s6, 64, s36
    s_cmp_eq_u32 s36, 0
    s_cselect_b32 s6, 32, s6
    s_cmp_eq_u32 s48, 0
    s_cselect_b32 s50, s36, s6
    s_lshl_b32 s51, s35, 1
    s_add_u32 s51, s51, s49
    s_lshl_b32 s41, s51, 7
    s_add_u32 s41, s41, 2252800
    v_lshlrev_b32 v205, 2, v4
    v_lshl_add_u32 v205, v5, 11, v205
    s_lshl_b32 s42, s3, 8
    s_add_u32 s42, s42, 126976
    v_lshl_add_u32 v206, v5, 4, s42
    s_lshl_b32 s7, s35, 6
    s_sub_u32 s6, 832, s7
    s_cmp_eq_u32 s49, 0
    s_cselect_b32 s7, s7, s6
    s_add_u32 s6, s7, 64
    s_cmp_eq_u32 s6, 896
    s_cselect_b32 s6, 448, s6
    s_cmp_eq_u32 s49, 0
    s_cselect_b32 s6, 0x7fff0000, s6
    v_mov_b32 v195, s6
    s_mul_i32 s43, s50, 896
    s_mul_i32 s44, s3, 3072
    s_add_u32 s44, s44, 151552
    v_add_u32 v192, 0, v2
    v_mul_u32_u24 v193, 205, v192
    v_lshrrev_b32 v193, 10, v193
    v_mul_u32_u24 v194, 5, v193
    v_sub_u32 v192, v192, v194
    v_cmp_eq_u32 vcc, 4, v192
    v_lshl_add_u32 v192, v192, 4, s7
    v_mul_u32_u24 v193, 57344, v193
    v_cndmask_b32 v192, v192, v195, vcc
    v_add_u32 v202, v192, v193
    v_add_u32 v192, 64, v2
    v_mul_u32_u24 v193, 205, v192
    v_lshrrev_b32 v193, 10, v193
    v_mul_u32_u24 v194, 5, v193
    v_sub_u32 v192, v192, v194
    v_cmp_eq_u32 vcc, 4, v192
    v_lshl_add_u32 v192, v192, 4, s7
    v_mul_u32_u24 v193, 57344, v193
    v_cndmask_b32 v192, v192, v195, vcc
    v_add_u32 v203, v192, v193
    v_add_u32 v192, 128, v2
    v_mul_u32_u24 v193, 205, v192
    v_lshrrev_b32 v193, 10, v193
    v_mul_u32_u24 v194, 5, v193
    v_sub_u32 v192, v192, v194
    v_cmp_eq_u32 vcc, 4, v192
    v_lshl_add_u32 v192, v192, 4, s7
    v_mul_u32_u24 v193, 57344, v193
    v_cndmask_b32 v192, v192, v195, vcc
    v_add_u32 v204, v192, v193
    s_add_u32 m0, s44, 0
    s_nop 0
    buffer_load_dwordx4 v202, s[8:11], s43 offen lds
    s_add_u32 m0, s44, 1024
    s_nop 0
    buffer_load_dwordx4 v203, s[8:11], s43 offen lds
    s_add_u32 m0, s44, 2048
    s_nop 0
    buffer_load_dwordx4 v204, s[8:11], s43 offen lds
    s_lshl_b32 s6, s48, 12
    v_lshlrev_b32 v9, 7, v4
    v_add_u32 v9, s6, v9
    v_bfe_u32 v194, v2, 1, 3
    v_xor_b32 v194, v194, v5
    v_lshl_add_u32 v9, v194, 4, v9
    v_xor_b32 v10, 32, v9
    v_xor_b32 v11, 64, v9
    v_xor_b32 v12, 96, v9
    s_lshl_b32 s6, s49, 12
    s_add_u32 s6, s6, 8192
    v_add_u32 v13, s6, v3
    s_cmp_eq_u32 s36, 0
    s_cselect_b32 s46, s48, 0
    s_add_u32 s6, s60, 114688
    v_add_u32 v0, s6, v3
    v_mov_b64 v[136:137], 0
    v_mov_b64 v[138:139], 0
    v_mov_b64 v[140:141], 0
    v_mov_b64 v[142:143], 0
    v_mov_b64 v[144:145], 0
    v_mov_b64 v[146:147], 0
    v_mov_b64 v[148:149], 0
    v_mov_b64 v[150:151], 0
    s_cmp_eq_u32 s51, 1
    s_cselect_b32 s6, 4096, 0
    s_cselect_b32 s45, 7, s35
    v_mov_b32 v192, s6
    v_cmp_eq_u32 vcc, 0, v4
    v_add_u32 v15, 118784, v3
    v_mul_u32_u24 v1, 80, v4
    v_cndmask_b32 v192, 0, v192, vcc
    v_add_u32 v14, v0, v192
    v_lshl_add_u32 v7, v192, 1, v3
    v_add_u32 v7, 114688, v7
    s_lshl_b32 s6, s46, 11
    v_add_u32 v6, s6, v7
    v_add_u32 v8, s6, v15
    v_add_u32 v1, s44, v1
    v_lshlrev_b32 v192, 3, v5
    v_sub_u32 v193, 10, v192
    s_lshl_b32 s45, s45, 7
    s_add_u32 s45, s45, 2244608
    s_cmp_eq_u32 s49, 0
    s_cselect_b64 vcc, -1, 0
    v_cndmask_b32 v192, v193, v192, vcc
    v_add_u32 v1, v1, v192
    s_lshl_b32 s6, s32, 1
    s_add_u32 s6, s6, s34
    s_lshl_b32 s6, s6, 1
    s_add_u32 s6, s6, s48
    s_mul_i32 s57, s6, 14
    s_add_u32 s57, s57, s51
    s_lshl_b32 s58, s57, 8
    s_add_u32 s58, s58, 2457600
    s_lshl_b32 s57, s57, 11
    s_add_u32 s59, s57, 6127616
    s_add_u32 s57, s57, 4292608
    v_lshlrev_b32 v207, 3, v4
    v_lshl_add_u32 v207, v5, 2, v207
    s_lshl_b32 s62, s34, 1
    s_xor_b32 s62, s62, s49
    s_or_b32 s63, s36, s48
    v_mov_b64 v[192:193], 0
    v_mov_b64 v[194:195], 0
    v_lshlrev_b32 v152, 6, v4
    v_add_u32 v152, s50, v152
    v_or_b32 v153, v152, v5
    v_cmp_eq_u32 vcc, 0, v153
    v_lshlrev_b32 v214, 2, v4
    v_mov_b32 v188, 0x45004500
    v_cvt_f32_u32 v152, v152
    v_cndmask_b32 v188, 0, v188, vcc
    v_mov_b32 v189, v188
    v_mov_b32 v190, v188
    s_load_dword s75, s[28:29], 0x0
    s_add_u32 m0, s60, 73728
    s_mov_b32 s61, 57344
    buffer_load_dwordx4 v208, s[16:19], s61 offen lds
    v_mov_b32 v191, v188
    v_mul_f32 v152, 0x3a000000, v152
    v_lshlrev_b32 v153, 2, v5
    v_cvt_f32_u32 v153, v153
    v_mul_f32 v153, v152, v153
    v_fmamk_f32 v154, v152, 0x00000000, v153
    v_fmamk_f32 v155, v152, 0x3f800000, v153
    v_cos_f32 v156, v154
    buffer_load_dwordx4 v208, s[20:23], s61 offen offset:1024 lds
    v_cos_f32 v157, v155
    v_sin_f32 v154, v154
    v_sin_f32 v155, v155
    v_cvt_pk_bf16_f32 v96, v156, v157
    s_add_u32 m0, s60, 81920
    s_nop 0
    buffer_load_dwordx4 v210, s[16:19], 0 offen lds
    v_cvt_pk_bf16_f32 v104, v154, v155
    v_fmamk_f32 v154, v152, 0x40000000, v153
    v_fmamk_f32 v155, v152, 0x40400000, v153
    v_cos_f32 v156, v154
    v_cos_f32 v157, v155
    v_sin_f32 v154, v154
    buffer_load_dwordx4 v210, s[20:23], 0 offen offset:1024 lds
    v_sin_f32 v155, v155
    v_cvt_pk_bf16_f32 v97, v156, v157
    v_cvt_pk_bf16_f32 v105, v154, v155
    v_fmamk_f32 v154, v152, 0x41000000, v153
    v_fmamk_f32 v155, v152, 0x41100000, v153
    v_cos_f32 v156, v154
    s_add_u32 m0, s60, 90112
    s_mov_b32 s61, 1494528
    buffer_load_dwordx4 v209, s[16:19], s61 offen lds
    v_cos_f32 v157, v155
    v_sin_f32 v154, v154
    v_sin_f32 v155, v155
    v_cvt_pk_bf16_f32 v98, v156, v157
    buffer_load_dwordx4 v209, s[20:23], s61 offen offset:1024 lds
    v_cvt_pk_bf16_f32 v106, v154, v155
    v_fmamk_f32 v154, v152, 0x41200000, v153
    v_fmamk_f32 v155, v152, 0x41300000, v153
    v_cos_f32 v156, v154
    v_cos_f32 v157, v155
    v_sin_f32 v154, v154
    s_waitcnt vmcnt(9) lgkmcnt(0)
    s_barrier
    s_cmp_lg_u32 s75, 0
    s_cbranch_scc1 BG_2
    s_mov_b32 s1, 0
    v_mov_b32 v74, 0
BS_1:
    s_sleep 8
    global_load_dword v75, v74, s[28:29] sc1
    s_add_u32 s1, s1, 1
    s_waitcnt vmcnt(0)
    v_readfirstlane_b32 s75, v75
    s_cmp_gt_u32 s1, 1048576
    s_cbranch_scc1 BG_2
    s_cmp_lg_u32 s75, 0
    s_cbranch_scc0 BS_1
BG_2:
    s_atomic_add s74, s[24:25], s40 offset:0
    s_atomic_add s74, s[24:25], s40 offset:1024
    s_atomic_add s74, s[24:25], s40 offset:2048
    s_atomic_add s74, s[24:25], s40 offset:3072
    s_add_u32 m0, s60, 98304
    s_mov_b32 s61, 114688
    buffer_load_dwordx4 v208, s[16:19], s61 offen lds
    v_sin_f32 v155, v155
    v_cvt_pk_bf16_f32 v99, v156, v157
    v_cvt_pk_bf16_f32 v107, v154, v155
    v_fmamk_f32 v154, v152, 0x41800000, v153
    buffer_load_dwordx4 v208, s[20:23], s61 offen offset:1024 lds
    v_fmamk_f32 v155, v152, 0x41880000, v153
    v_cos_f32 v156, v154
    v_cos_f32 v157, v155
    v_sin_f32 v154, v154
    s_add_u32 m0, s60, 106496
    s_mov_b32 s61, 172032
    buffer_load_dwordx4 v208, s[16:19], s61 offen lds
    v_sin_f32 v155, v155
    v_cvt_pk_bf16_f32 v100, v156, v157
    v_cvt_pk_bf16_f32 v108, v154, v155
    v_fmamk_f32 v154, v152, 0x41900000, v153
    buffer_load_dwordx4 v208, s[20:23], s61 offen offset:1024 lds
    v_fmamk_f32 v155, v152, 0x41980000, v153
    v_cos_f32 v156, v154
    v_cos_f32 v157, v155
    v_sin_f32 v154, v154
    s_add_u32 m0, s60, 114688
    s_mov_b32 s61, 1437184
    buffer_load_dwordx4 v209, s[16:19], s61 offen lds
    v_sin_f32 v155, v155
    v_cvt_pk_bf16_f32 v101, v156, v157
    v_cvt_pk_bf16_f32 v109, v154, v155
    v_fmamk_f32 v154, v152, 0x41c00000, v153
    buffer_load_dwordx4 v209, s[20:23], s61 offen offset:1024 lds
    v_fmamk_f32 v155, v152, 0x41c80000, v153
    v_cos_f32 v156, v154
    v_cos_f32 v157, v155
    v_sin_f32 v154, v154
    s_add_u32 m0, s60, 122880
    s_mov_b32 s61, 1379840
    buffer_load_dwordx4 v209, s[16:19], s61 offen lds
    v_sin_f32 v155, v155
    v_cvt_pk_bf16_f32 v102, v156, v157
    v_cvt_pk_bf16_f32 v110, v154, v155
    v_fmamk_f32 v154, v152, 0x41d00000, v153
    buffer_load_dwordx4 v209, s[20:23], s61 offen offset:1024 lds
    v_fmamk_f32 v155, v152, 0x41d80000, v153
    v_cos_f32 v156, v154
    v_cos_f32 v157, v155
    v_sin_f32 v154, v154
    s_add_u32 m0, s60, 131072
    s_mov_b32 s61, 229376
    buffer_load_dwordx4 v208, s[16:19], s61 offen lds
    v_sin_f32 v155, v155
    v_cvt_pk_bf16_f32 v103, v156, v157
    v_cvt_pk_bf16_f32 v111, v154, v155
    s_cmp_eq_u32 s36, 0
    s_cselect_b32 s73, 0, -1
    buffer_load_dwordx4 v208, s[20:23], s61 offen offset:1024 lds
    v_mov_b32 v152, s73
    s_mul_i32 s73, s48, 0x80008000
    s_mul_i32 s38, s49, 0x80008000
    s_xor_b32 s37, s38, 0x80008000
    s_xor_b32 s38, s38, s73
    s_add_u32 m0, s60, 139264
    s_mov_b32 s61, 286720
    buffer_load_dwordx4 v208, s[16:19], s61 offen lds
    v_bitop3_b32 v112, v104, s73, v152 bitop3:0x28
    v_xor_b32 v120, s37, v104
    v_bitop3_b32 v128, v96, s38, v152 bitop3:0x28
    v_bitop3_b32 v113, v105, s73, v152 bitop3:0x28
    v_xor_b32 v121, s37, v105
    v_bitop3_b32 v129, v97, s38, v152 bitop3:0x28
    s_mov_b32 s76, -1
    s_atomic_and s76, s[24:25], s53 glc
    s_mov_b32 s78, 36
    s_mov_b32 s4, 0
    s_cmp_eq_u32 s3, 3
    s_cbranch_scc1 B0_3
    s_mov_b32 s78, -1
    s_atomic_and s78, s[24:25], s56 glc
B0_3:
    buffer_load_dwordx4 v208, s[20:23], s61 offen offset:1024 lds
    v_bitop3_b32 v114, v106, s73, v152 bitop3:0x28
    v_xor_b32 v122, s37, v106
    v_bitop3_b32 v130, v98, s38, v152 bitop3:0x28
    v_bitop3_b32 v115, v107, s73, v152 bitop3:0x28
    v_xor_b32 v123, s37, v107
    v_bitop3_b32 v131, v99, s38, v152 bitop3:0x28
    s_branch PL_2
PE_2:
    .p2align 12
PT_2:
    s_branch PL_1
    s_nop 0
PL_2:
    s_barrier
    s_mov_b64 exec, 0x3fff
    global_load_dword a252, v252, s[26:27]
    s_mov_b64 exec, -1
    global_load_dword v216, v224, s[82:83] offset:0
    global_load_dword v217, v224, s[82:83] offset:896
    global_load_dword v218, v224, s[82:83] offset:1792
    global_load_dword v219, v224, s[82:83] offset:2688
    global_load_dword v220, v225, s[82:83] offset:0
    global_load_dword v221, v225, s[82:83] offset:896
    global_load_dword v222, v225, s[82:83] offset:1792
    global_load_dword v223, v225, s[82:83] offset:2688
    s_mov_b32 s77, -1
    s_atomic_and s77, s[24:25], s53 glc
    s_cmp_eq_u32 s3, 3
    s_cbranch_scc1 B0_4
    s_mov_b32 s4, -1
    s_atomic_and s4, s[24:25], s56 glc
B0_4:
    s_waitcnt vmcnt(27)
    s_cmp_eq_u32 s49, 0
    s_cbranch_scc0 P2xa_5
    ds_read_u16_d16_hi v136, v1 offset:0
    ds_read_u16_d16_hi v137, v1 offset:2
    ds_read_u16_d16_hi v138, v1 offset:4
    ds_read_u16_d16_hi v139, v1 offset:6
    ds_read_u16_d16_hi v140, v1 offset:16
    ds_read_u16_d16_hi v141, v1 offset:18
    ds_read_u16_d16_hi v142, v1 offset:20
    ds_read_u16_d16_hi v143, v1 offset:22
    ds_read_u16_d16_hi v144, v1 offset:32
    ds_read_u16_d16_hi v145, v1 offset:34
    ds_read_u16_d16_hi v146, v1 offset:36
    ds_read_u16_d16_hi v147, v1 offset:38
    ds_read_u16_d16_hi v148, v1 offset:48
    ds_read_u16_d16_hi v149, v1 offset:50
    ds_read_u16_d16_hi v150, v1 offset:52
    ds_read_u16_d16_hi v151, v1 offset:54
    s_branch P2xb_6
P2xa_5:
    ds_read_u16_d16_hi v136, v1 offset:54
    ds_read_u16_d16_hi v137, v1 offset:52
    ds_read_u16_d16_hi v138, v1 offset:50
    ds_read_u16_d16_hi v139, v1 offset:48
    ds_read_u16_d16_hi v140, v1 offset:38
    ds_read_u16_d16_hi v141, v1 offset:36
    ds_read_u16_d16_hi v142, v1 offset:34
    ds_read_u16_d16_hi v143, v1 offset:32
    ds_read_u16_d16_hi v144, v1 offset:22
    ds_read_u16_d16_hi v145, v1 offset:20
    ds_read_u16_d16_hi v146, v1 offset:18
    ds_read_u16_d16_hi v147, v1 offset:16
    ds_read_u16_d16_hi v148, v1 offset:6
    ds_read_u16_d16_hi v149, v1 offset:4
    ds_read_u16_d16_hi v150, v1 offset:2
    ds_read_u16_d16_hi v151, v1 offset:0
P2xb_6:
    ds_read_b32 v16, v3
    ds_read_b32 v16, v3
    ds_read_b32 v16, v3
    ds_read_b32 v16, v3
    ds_read_b32 v16, v3
    ds_read_b32 v16, v3
    ds_read_b32 v16, v3
    ds_read_b32 v16, v3
    s_waitcnt lgkmcnt(8)
    s_mov_b32 s1, 15
B1_7:
    s_max_i32 s6, s76, s77
    s_max_i32 s7, s78, s4
    s_min_i32 s0, s6, s7
    s_cmp_eq_u32 s0, 36
    s_cbranch_scc1 B1D_8
    s_add_u32 s1, s1, 1
    s_and_b32 s0, s1, 7
    s_cbranch_scc1 B1_7
    s_cmp_gt_u32 s1, 8388608
    s_cbranch_scc1 B1D_8
    s_and_b32 s0, s1, 8
    s_cbranch_scc1 B1B_9
    s_cmp_eq_u32 s6, 36
    s_cbranch_scc1 B1S_10
    s_cmp_ge_u32 s76, 36
    s_cbranch_scc1 B1S_10
    s_mov_b32 s76, -1
    s_atomic_and s76, s[24:25], s53 glc
B1S_10:
    s_cmp_eq_u32 s7, 36
    s_cbranch_scc1 B1S_11
    s_cmp_ge_u32 s78, 36
    s_cbranch_scc1 B1S_11
    s_mov_b32 s78, -1
    s_atomic_and s78, s[24:25], s56 glc
B1S_11:
    s_branch B1_7
B1B_9:
    s_cmp_eq_u32 s6, 36
    s_cbranch_scc1 B1S_12
    s_cmp_ge_u32 s77, 36
    s_cbranch_scc1 B1S_12
    s_mov_b32 s77, -1
    s_atomic_and s77, s[24:25], s53 glc
B1S_12:
    s_cmp_eq_u32 s7, 36
    s_cbranch_scc1 B1S_13
    s_cmp_ge_u32 s4, 36
    s_cbranch_scc1 B1S_13
    s_mov_b32 s4, -1
    s_atomic_and s4, s[24:25], s56 glc
B1S_13:
    s_branch B1_7
B1D_8:
    s_mov_b32 m0, s60
    s_waitcnt vmcnt(9)
    s_barrier
    buffer_load_dwordx4 v200, s[12:15], s52 offen sc1 lds
    buffer_load_dwordx4 v201, s[12:15], s52 offen offset:1024 sc1 lds
    s_add_u32 m0, s60, 8192
    s_nop 0
    buffer_load_dwordx4 v3, s[12:15], s55 offen sc1 lds
    buffer_load_dwordx4 v3, s[12:15], s55 offen offset:1024 sc1 lds
    ds_read_b64_tr_b16 a[0:1], v211 offset:0
    ds_read_b64_tr_b16 a[2:3], v211 offset:4096
    ds_read_b64_tr_b16 a[4:5], v211 offset:1024
    ds_read_b64_tr_b16 a[6:7], v211 offset:5120
    v_bitop3_b32 v116, v108, s73, v152 bitop3:0x28
    v_xor_b32 v124, s37, v108
    v_bitop3_b32 v132, v100, s38, v152 bitop3:0x28
    v_bitop3_b32 v117, v109, s73, v152 bitop3:0x28
    s_add_u32 m0, s60, 16384
    s_add_u32 s52, s52, 128
    s_add_u32 s55, s55, 4096
    s_cmp_eq_u32 s52, s72
    s_cselect_b32 s52, s70, s52
    s_cselect_b32 s55, s71, s55
    buffer_load_dwordx4 v200, s[12:15], s52 offen sc1 lds
    ds_read_b64_tr_b16 a[8:9], v211 offset:8192
    ds_read_b64_tr_b16 a[10:11], v211 offset:12288
    ds_read_b64_tr_b16 a[12:13], v211 offset:9216
    ds_read_b64_tr_b16 a[14:15], v211 offset:13312
    v_xor_b32 v125, s37, v109
    v_bitop3_b32 v133, v101, s38, v152 bitop3:0x28
    v_bitop3_b32 v118, v110, s73, v152 bitop3:0x28
    v_xor_b32 v126, s37, v110
    buffer_load_dwordx4 v201, s[12:15], s52 offen offset:1024 sc1 lds
    ds_read_b64_tr_b16 a[16:17], v211 offset:16384
    ds_read_b64_tr_b16 a[18:19], v211 offset:20480
    ds_read_b64_tr_b16 a[20:21], v211 offset:17408
    ds_read_b64_tr_b16 a[22:23], v211 offset:21504
    v_bitop3_b32 v134, v102, s38, v152 bitop3:0x28
    v_bitop3_b32 v119, v111, s73, v152 bitop3:0x28
    v_xor_b32 v127, s37, v111
    v_bitop3_b32 v135, v103, s38, v152 bitop3:0x28
    s_add_u32 m0, s60, 24576
    s_nop 0
    buffer_load_dwordx4 v3, s[12:15], s55 offen sc1 lds
    ds_read_b64_tr_b16 a[24:25], v211 offset:24576
    ds_read_b64_tr_b16 a[26:27], v211 offset:28672
    ds_read_b64_tr_b16 a[28:29], v211 offset:25600
    ds_read_b64_tr_b16 a[30:31], v211 offset:29696
    buffer_load_dwordx4 v3, s[12:15], s55 offen offset:1024 sc1 lds
    ds_read_b64_tr_b16 a[32:33], v211 offset:32768
    ds_read_b64_tr_b16 a[34:35], v211 offset:36864
    ds_read_b64_tr_b16 a[36:37], v211 offset:33792
    ds_read_b64_tr_b16 a[38:39], v211 offset:37888
    s_add_u32 m0, s60, 32768
    s_add_u32 s52, s52, 128
    s_add_u32 s55, s55, 4096
    s_cmp_eq_u32 s52, s72
    s_cselect_b32 s52, s70, s52
    s_cselect_b32 s55, s71, s55
    buffer_load_dwordx4 v200, s[12:15], s52 offen sc1 lds
    ds_read_b64_tr_b16 a[40:41], v211 offset:40960
    ds_read_b64_tr_b16 a[42:43], v211 offset:45056
    ds_read_b64_tr_b16 a[44:45], v211 offset:41984
    ds_read_b64_tr_b16 a[46:47], v211 offset:46080
    buffer_load_dwordx4 v201, s[12:15], s52 offen offset:1024 sc1 lds
    ds_read_b64_tr_b16 a[48:49], v211 offset:49152
    ds_read_b64_tr_b16 a[50:51], v211 offset:53248
    ds_read_b64_tr_b16 a[52:53], v211 offset:50176
    ds_read_b64_tr_b16 a[54:55], v211 offset:54272
    s_add_u32 m0, s60, 40960
    s_nop 0
    buffer_load_dwordx4 v3, s[12:15], s55 offen sc1 lds
    ds_read_b64_tr_b16 a[56:57], v211 offset:57344
    ds_read_b64_tr_b16 a[58:59], v211 offset:61440
    ds_read_b64_tr_b16 a[60:61], v211 offset:58368
    ds_read_b64_tr_b16 a[62:63], v211 offset:62464
    buffer_load_dwordx4 v3, s[12:15], s55 offen offset:1024 sc1 lds
    ds_read_b64_tr_b16 a[64:65], v212 offset:0
    ds_read_b64_tr_b16 a[66:67], v212 offset:4096
    ds_read_b64_tr_b16 a[68:69], v212 offset:1024
    ds_read_b64_tr_b16 a[70:71], v212 offset:5120
    s_add_u32 m0, s60, 49152
    s_add_u32 s52, s52, 128
    s_add_u32 s55, s55, 4096
    s_cmp_eq_u32 s52, s72
    s_cselect_b32 s52, s70, s52
    s_cselect_b32 s55, s71, s55
    buffer_load_dwordx4 v200, s[12:15], s52 offen sc1 lds
    ds_read_b64_tr_b16 a[72:73], v212 offset:8192
    ds_read_b64_tr_b16 a[74:75], v212 offset:12288
    ds_read_b64_tr_b16 a[76:77], v212 offset:9216
    ds_read_b64_tr_b16 a[78:79], v212 offset:13312
    buffer_load_dwordx4 v201, s[12:15], s52 offen offset:1024 sc1 lds
    s_add_u32 m0, s60, 57344
    s_nop 0
    buffer_load_dwordx4 v3, s[12:15], s55 offen sc1 lds
    buffer_load_dwordx4 v3, s[12:15], s55 offen offset:1024 sc1 lds
    ds_read_b32 v16, v3
    ds_read_b32 v16, v3
    ds_read_b32 v16, v3
    ds_read_b32 v16, v3
    s_waitcnt lgkmcnt(4)
    s_barrier
    s_cmp_lg_u32 s3, 3
    s_cbranch_scc1 PI_14
    s_mov_b32 s47, 0
    s_atomic_add s47, s[24:25], s68 glc
PI_14:
    s_add_u32 m0, s60, 65536
    s_add_u32 s52, s52, 128
    s_add_u32 s55, s55, 4096
    s_cmp_eq_u32 s52, s72
    s_cselect_b32 s52, s70, s52
    s_cselect_b32 s55, s71, s55
    buffer_load_dwordx4 v200, s[12:15], s52 offen sc1 lds
    ds_write_b128 v0, v[192:195] offset:0
    v_subrev_u32 v211, 65536, v211
    buffer_load_dwordx4 v201, s[12:15], s52 offen offset:1024 sc1 lds
    ds_write_b128 v0, v[192:195] offset:1024
    v_subrev_u32 v212, 65536, v212
    v_add_u32 v213, 0x10000, v212
    s_add_u32 m0, s60, 73728
    s_nop 0
    buffer_load_dwordx4 v3, s[12:15], s55 offen sc1 lds
    buffer_load_dwordx4 v3, s[12:15], s55 offen offset:1024 sc1 lds
    s_waitcnt vmcnt(16)
    s_barrier
    s_add_u32 m0, s60, 81920
    s_add_u32 s52, s52, 128
    s_add_u32 s55, s55, 4096
    s_cmp_eq_u32 s52, s72
    s_cselect_b32 s52, s70, s52
    s_cselect_b32 s55, s71, s55
    buffer_load_dwordx4 v200, s[12:15], s52 offen sc1 lds
    ds_read_b128 v[32:35], v9 offset:0
    ds_read_b128 v[36:39], v13 offset:0
    buffer_load_dwordx4 v201, s[12:15], s52 offen offset:1024 sc1 lds
    ds_read_b128 v[40:43], v10 offset:0
    ds_read_b128 v[44:47], v13 offset:1024
    s_add_u32 m0, s60, 90112
    s_nop 0
    buffer_load_dwordx4 v3, s[12:15], s55 offen sc1 lds
    ds_read_b128 v[48:51], v11 offset:0
    ds_read_b128 v[52:55], v13 offset:2048
    buffer_load_dwordx4 v3, s[12:15], s55 offen offset:1024 sc1 lds
    ds_read_b128 v[56:59], v12 offset:0
    ds_read_b128 v[60:63], v13 offset:3072
    s_waitcnt vmcnt(16)
    s_barrier
    s_waitcnt lgkmcnt(6)
    v_mfma_f32_32x32x16_bf16 v[16:31], v[32:35], v[36:39], 0
    s_add_u32 m0, s60, 98304
    s_add_u32 s52, s52, 128
    s_add_u32 s55, s55, 4096
    s_cmp_eq_u32 s52, s72
    s_cselect_b32 s52, s70, s52
    s_cselect_b32 s55, s71, s55
    buffer_load_dwordx4 v200, s[12:15], s52 offen sc1 lds
    ds_read_b128 v[64:67], v9 offset:16384
    ds_read_b128 v[68:71], v13 offset:16384
    s_waitcnt lgkmcnt(6)
    v_mfma_f32_32x32x16_bf16 v[16:31], v[40:43], v[44:47], v[16:31]
    buffer_load_dwordx4 v201, s[12:15], s52 offen offset:1024 sc1 lds
    ds_read_b128 v[72:75], v10 offset:16384
    ds_read_b128 v[76:79], v13 offset:17408
    s_waitcnt lgkmcnt(6)
    v_mfma_f32_32x32x16_bf16 v[16:31], v[48:51], v[52:55], v[16:31]
    s_add_u32 m0, s60, 106496
    s_nop 0
    buffer_load_dwordx4 v3, s[12:15], s55 offen sc1 lds
    ds_read_b128 v[80:83], v11 offset:16384
    ds_read_b128 v[84:87], v13 offset:18432
    s_waitcnt lgkmcnt(6)
    v_mfma_f32_32x32x16_bf16 v[16:31], v[56:59], v[60:63], v[16:31]
    buffer_load_dwordx4 v3, s[12:15], s55 offen offset:1024 sc1 lds
    ds_read_b128 v[88:91], v12 offset:16384
    ds_read_b128 v[92:95], v13 offset:19456
    s_waitcnt vmcnt(16)
    s_barrier
    s_waitcnt lgkmcnt(6)
    v_mfma_f32_32x32x16_bf16 v[16:31], v[64:67], v[68:71], v[16:31]
    ds_read_b128 v[32:35], v9 offset:32768
    ds_read_b128 v[36:39], v13 offset:32768
    s_waitcnt lgkmcnt(6)
    v_mfma_f32_32x32x16_bf16 v[16:31], v[72:75], v[76:79], v[16:31]
    s_add_u32 m0, s60, 0
    s_mov_b32 s61, 1322496
    buffer_load_dwordx4 v209, s[16:19], s61 offen lds
    ds_read_b128 v[40:43], v10 offset:32768
    ds_read_b128 v[44:47], v13 offset:33792
    s_waitcnt lgkmcnt(6)
    v_mfma_f32_32x32x16_bf16 v[16:31], v[80:83], v[84:87], v[16:31]
    ds_read_b128 v[48:51], v11 offset:32768
    ds_read_b128 v[52:55], v13 offset:34816
    s_waitcnt lgkmcnt(6)
    v_mfma_f32_32x32x16_bf16 v[16:31], v[88:91], v[92:95], v[16:31]
    buffer_load_dwordx4 v209, s[20:23], s61 offen offset:1024 lds
    ds_read_b128 v[56:59], v12 offset:32768
    ds_read_b128 v[60:63], v13 offset:35840
    s_waitcnt vmcnt(14)
    s_barrier
    s_waitcnt lgkmcnt(6)
    v_mfma_f32_32x32x16_bf16 v[16:31], v[32:35], v[36:39], v[16:31]
    ds_read_b128 v[64:67], v9 offset:49152
    ds_read_b128 v[68:71], v13 offset:49152
    v_add_u32 v9, 0x10000, v9
    s_waitcnt lgkmcnt(6)
    v_mfma_f32_32x32x16_bf16 v[16:31], v[40:43], v[44:47], v[16:31]
    s_add_u32 m0, s60, 8192
    s_mov_b32 s61, 1265152
    buffer_load_dwordx4 v209, s[16:19], s61 offen lds
    ds_read_b128 v[72:75], v10 offset:49152
    ds_read_b128 v[76:79], v13 offset:50176
    v_add_u32 v10, 0x10000, v10
    s_waitcnt lgkmcnt(6)
    v_mfma_f32_32x32x16_bf16 v[16:31], v[48:51], v[52:55], v[16:31]
    ds_read_b128 v[80:83], v11 offset:49152
    ds_read_b128 v[84:87], v13 offset:51200
    v_add_u32 v11, 0x10000, v11
    s_waitcnt lgkmcnt(6)
    v_mfma_f32_32x32x16_bf16 v[16:31], v[56:59], v[60:63], v[16:31]
    buffer_load_dwordx4 v209, s[20:23], s61 offen offset:1024 lds
    ds_read_b128 v[88:91], v12 offset:49152
    ds_read_b128 v[92:95], v13 offset:52224
    v_add_u32 v12, 0x10000, v12
    v_add_u32 v13, 0x10000, v13
    s_cmp_eq_u32 s63, 0
    s_cselect_b64 vcc, -1, 0
    s_cbranch_vccnz ZA_15
ZA_15R:
    s_cmp_lg_u32 s3, 3
    s_cbranch_scc1 PD_21
    s_mov_b32 s1, 0
PC_20:
    s_waitcnt lgkmcnt(0)
    s_cmp_ge_u32 s47, 28
    s_cbranch_scc1 PD_21
    s_add_u32 s1, s1, 1
    s_cmp_gt_u32 s1, 1048576
    s_cbranch_scc1 PD_21
    s_mov_b32 s47, 0
    s_atomic_add s47, s[24:25], s68 glc
    s_branch PC_20
PD_21:
    s_waitcnt vmcnt(12)
    s_barrier
    s_waitcnt lgkmcnt(6)
    v_mfma_f32_32x32x16_bf16 v[16:31], v[64:67], v[68:71], v[16:31]
    s_mov_b32 m0, s42
    s_nop 0
    buffer_load_dword v205, s[12:15], s41 offen sc1 lds
    ds_read_b128 v[32:35], v9 offset:0
    ds_read_b128 v[36:39], v13 offset:0
    s_waitcnt lgkmcnt(6)
    v_mfma_f32_32x32x16_bf16 v[16:31], v[72:75], v[76:79], v[16:31]
    s_add_u32 m0, s60, 16384
    s_mov_b32 s61, 344064
    buffer_load_dwordx4 v208, s[16:19], s61 offen lds
    ds_read_b128 v[40:43], v10 offset:0
    ds_read_b128 v[44:47], v13 offset:1024
    s_waitcnt lgkmcnt(6)
    v_mfma_f32_32x32x16_bf16 v[16:31], v[80:83], v[84:87], v[16:31]
    ds_read_b128 v[48:51], v11 offset:0
    ds_read_b128 v[52:55], v13 offset:2048
    s_waitcnt lgkmcnt(6)
    v_mfma_f32_32x32x16_bf16 v[16:31], v[88:91], v[92:95], v[16:31]
    buffer_load_dwordx4 v208, s[20:23], s61 offen offset:1024 lds
    ds_read_b128 v[56:59], v12 offset:0
    ds_read_b128 v[60:63], v13 offset:3072
    s_waitcnt vmcnt(11)
    s_barrier
    s_waitcnt lgkmcnt(6)
    v_mfma_f32_32x32x16_bf16 v[16:31], v[32:35], v[36:39], v[16:31]
    ds_read_b128 v[64:67], v9 offset:16384
    ds_read_b128 v[68:71], v13 offset:16384
    s_waitcnt lgkmcnt(6)
    v_mfma_f32_32x32x16_bf16 v[16:31], v[40:43], v[44:47], v[16:31]
    s_add_u32 m0, s60, 24576
    s_mov_b32 s61, 401408
    buffer_load_dwordx4 v208, s[16:19], s61 offen lds
    ds_read_b128 v[72:75], v10 offset:16384
    ds_read_b128 v[76:79], v13 offset:17408
    s_waitcnt lgkmcnt(6)
    v_mfma_f32_32x32x16_bf16 v[16:31], v[48:51], v[52:55], v[16:31]
    ds_read_b128 v[80:83], v11 offset:16384
    ds_read_b128 v[84:87], v13 offset:18432
    s_waitcnt lgkmcnt(6)
    v_mfma_f32_32x32x16_bf16 v[16:31], v[56:59], v[60:63], v[16:31]
    buffer_load_dwordx4 v208, s[20:23], s61 offen offset:1024 lds
    ds_read_b128 v[88:91], v12 offset:16384
    ds_read_b128 v[92:95], v13 offset:19456
    s_waitcnt vmcnt(9)
    s_barrier
    s_waitcnt lgkmcnt(6)
    v_mfma_f32_32x32x16_bf16 v[16:31], v[64:67], v[68:71], v[16:31]
    ds_read_b128 v[32:35], v9 offset:32768
    ds_read_b128 v[36:39], v13 offset:32768
    s_waitcnt lgkmcnt(6)
    v_mfma_f32_32x32x16_bf16 v[16:31], v[72:75], v[76:79], v[16:31]
    s_add_u32 m0, s60, 32768
    s_mov_b32 s61, 1207808
    buffer_load_dwordx4 v209, s[16:19], s61 offen lds
    ds_read_b128 v[40:43], v10 offset:32768
    ds_read_b128 v[44:47], v13 offset:33792
    s_waitcnt lgkmcnt(6)
    v_mfma_f32_32x32x16_bf16 v[16:31], v[80:83], v[84:87], v[16:31]
    ds_read_b128 v[48:51], v11 offset:32768
    ds_read_b128 v[52:55], v13 offset:34816
    s_waitcnt lgkmcnt(6)
    v_mfma_f32_32x32x16_bf16 v[16:31], v[88:91], v[92:95], v[16:31]
    buffer_load_dwordx4 v209, s[20:23], s61 offen offset:1024 lds
    ds_read_b128 v[56:59], v12 offset:32768
    ds_read_b128 v[60:63], v13 offset:35840
    s_cbranch_vccnz ZB_16
ZB_16R:
    s_waitcnt lgkmcnt(6)
    v_mfma_f32_32x32x16_bf16 v[16:31], v[32:35], v[36:39], v[16:31]
    v_perm_b32 v224, v217, v216, s65
    v_perm_b32 v225, v219, v218, s65
    v_perm_b32 v226, v221, v220, s65
    v_perm_b32 v227, v223, v222, s65
    v_perm_b32 v228, v217, v216, s66
    v_perm_b32 v229, v219, v218, s66
    v_perm_b32 v230, v221, v220, s66
    v_perm_b32 v231, v223, v222, s66
    s_waitcnt lgkmcnt(4)
    v_mfma_f32_32x32x16_bf16 v[16:31], v[40:43], v[44:47], v[16:31]
    buffer_store_dwordx4 v[224:227], v232, s[12:15], s64 offen offset:0 sc1
    s_waitcnt lgkmcnt(2)
    v_mfma_f32_32x32x16_bf16 v[16:31], v[48:51], v[52:55], v[16:31]
    buffer_store_dwordx4 v[228:231], v232, s[12:15], s64 offen offset:1024 sc1
    s_waitcnt lgkmcnt(0)
    v_mfma_f32_32x32x16_bf16 v[16:31], v[56:59], v[60:63], v[16:31]
    s_add_u32 m0, s60, 40960
    s_mov_b32 s61, 1150464
    buffer_load_dwordx4 v209, s[16:19], s61 offen lds
    buffer_load_dwordx4 v209, s[20:23], s61 offen offset:1024 lds
    s_nop 7
    v_cvt_pk_bf16_f32 v192, v16, v17
    v_cvt_pk_bf16_f32 v193, v18, v19
    v_cvt_pk_bf16_f32 v194, v20, v21
    v_cvt_pk_bf16_f32 v195, v22, v23
    ds_write_b128 v14, v[192:195] offset:0
    v_cvt_pk_bf16_f32 v196, v24, v25
    v_cvt_pk_bf16_f32 v197, v26, v27
    v_cvt_pk_bf16_f32 v198, v28, v29
    v_cvt_pk_bf16_f32 v199, v30, v31
    ds_write_b128 v14, v[196:199] offset:1024
    s_add_u32 m0, s60, 49152
    s_mov_b32 s61, 458752
    buffer_load_dwordx4 v208, s[16:19], s61 offen lds
    buffer_load_dwordx4 v208, s[20:23], s61 offen offset:1024 lds
    s_waitcnt lgkmcnt(0)
    s_barrier
    ds_read_b128 v[32:35], v6 offset:0
    ds_read_b128 v[36:39], v6 offset:1024
    ds_read_b128 v[40:43], v7 offset:2048
    ds_read_b128 v[44:47], v7 offset:3072
    s_add_u32 m0, s60, 57344
    s_mov_b32 s61, 516096
    buffer_load_dwordx4 v208, s[16:19], s61 offen lds
    s_waitcnt lgkmcnt(3)
    v_mfma_f32_32x32x16_bf16 v[16:31], v[32:35], v[96:99], 0
    ds_read_b128 v[48:51], v8 offset:0
    ds_read_b128 v[52:55], v8 offset:1024
    s_waitcnt lgkmcnt(4)
    v_mfma_f32_32x32x16_bf16 v[16:31], v[36:39], v[100:103], v[16:31]
    ds_read_b128 v[56:59], v15 offset:2048
    ds_read_b128 v[60:63], v15 offset:3072
    s_waitcnt lgkmcnt(5)
    v_mfma_f32_32x32x16_bf16 v[16:31], v[40:43], v[112:115], v[16:31]
    buffer_load_dwordx4 v208, s[20:23], s61 offen offset:1024 lds
    s_waitcnt lgkmcnt(4)
    v_mfma_f32_32x32x16_bf16 v[16:31], v[44:47], v[116:119], v[16:31]
    s_waitcnt vmcnt(14)
    ds_read_b128 v[152:155], v206 offset:0
    ds_read_b128 v[168:171], v206 offset:128
    s_waitcnt lgkmcnt(5)
    v_mfma_f32_32x32x16_bf16 v[16:31], v[48:51], v[120:123], v[16:31]
    s_add_u32 m0, s60, 65536
    s_mov_b32 s61, 1093120
    buffer_load_dwordx4 v209, s[16:19], s61 offen lds
    ds_read_b128 v[156:159], v206 offset:32
    ds_read_b128 v[172:175], v206 offset:160
    s_waitcnt lgkmcnt(6)
    v_mfma_f32_32x32x16_bf16 v[16:31], v[52:55], v[124:127], v[16:31]
    ds_read_b128 v[160:163], v206 offset:64
    ds_read_b128 v[176:179], v206 offset:192
    s_waitcnt lgkmcnt(7)
    v_mfma_f32_32x32x16_bf16 v[16:31], v[56:59], v[128:131], v[16:31]
    buffer_load_dwordx4 v209, s[20:23], s61 offen offset:1024 lds
    ds_read_b128 v[164:167], v206 offset:96
    ds_read_b128 v[180:183], v206 offset:224
    s_waitcnt lgkmcnt(8)
    v_mfma_f32_32x32x16_bf16 v[16:31], v[60:63], v[132:135], v[16:31]
    s_cbranch_vccnz ZE_19
ZE_19R:
    s_waitcnt lgkmcnt(0)
    s_nop 9
    v_pk_fma_f32 v[136:137], v[16:17], v[152:153], v[136:137]
    v_pk_fma_f32 v[138:139], v[18:19], v[154:155], v[138:139]
    v_pk_fma_f32 v[140:141], v[20:21], v[156:157], v[140:141]
    v_pk_fma_f32 v[142:143], v[22:23], v[158:159], v[142:143]
    v_pk_mul_f32 v[168:169], v[168:169], v[136:137]
    v_pk_mul_f32 v[170:171], v[170:171], v[138:139]
    v_pk_mul_f32 v[172:173], v[172:173], v[140:141]
    v_pk_mul_f32 v[174:175], v[174:175], v[142:143]
    v_cvt_pk_bf16_f32 v32, v168, v169
    v_cvt_pk_bf16_f32 v33, v170, v171
    v_cvt_pk_bf16_f32 v34, v172, v173
    v_cvt_pk_bf16_f32 v35, v174, v175
    buffer_store_dwordx4 v[32:35], v3, s[12:15], s57 offen offset:0 sc1
    v_pk_fma_f32 v[144:145], v[24:25], v[160:161], v[144:145]
    v_pk_fma_f32 v[146:147], v[26:27], v[162:163], v[146:147]
    v_pk_fma_f32 v[148:149], v[28:29], v[164:165], v[148:149]
    v_pk_fma_f32 v[150:151], v[30:31], v[166:167], v[150:151]
    v_pk_mul_f32 v[176:177], v[176:177], v[144:145]
    v_pk_mul_f32 v[178:179], v[178:179], v[146:147]
    v_pk_mul_f32 v[180:181], v[180:181], v[148:149]
    v_pk_mul_f32 v[182:183], v[182:183], v[150:151]
    v_cvt_pk_bf16_f32 v36, v176, v177
    v_cvt_pk_bf16_f32 v37, v178, v179
    v_cvt_pk_bf16_f32 v38, v180, v181
    v_cvt_pk_bf16_f32 v39, v182, v183
    buffer_store_dwordx4 v[36:39], v3, s[12:15], s57 offen offset:1024 sc1
    v_pk_add_f32 v[192:193], v[136:137], v[138:139]
    v_pk_mul_f32 v[194:195], v[136:137], v[136:137]
    v_pk_fma_f32 v[194:195], v[138:139], v[138:139], v[194:195]
    v_pk_add_f32 v[192:193], v[192:193], v[140:141]
    v_pk_fma_f32 v[194:195], v[140:141], v[140:141], v[194:195]
    v_pk_add_f32 v[192:193], v[192:193], v[142:143]
    v_pk_fma_f32 v[194:195], v[142:143], v[142:143], v[194:195]
    v_pk_add_f32 v[192:193], v[192:193], v[144:145]
    v_pk_fma_f32 v[194:195], v[144:145], v[144:145], v[194:195]
    v_pk_add_f32 v[192:193], v[192:193], v[146:147]
    v_pk_fma_f32 v[194:195], v[146:147], v[146:147], v[194:195]
    v_pk_add_f32 v[192:193], v[192:193], v[148:149]
    v_pk_fma_f32 v[194:195], v[148:149], v[148:149], v[194:195]
    v_pk_add_f32 v[192:193], v[192:193], v[150:151]
    v_pk_fma_f32 v[194:195], v[150:151], v[150:151], v[194:195]
    v_add_f32 v192, v192, v193
    v_add_f32 v193, v194, v195
    v_cvt_pk_bf16_f32 v216, v136, v137
    v_cvt_pk_bf16_f32 v217, v138, v139
    v_permlane32_swap_b32 v192, v193
    v_add_f32 v192, v192, v193
    buffer_store_dword v192, v207, s[12:15], s58 offen sc1
    v_cvt_pk_bf16_f32 v218, v140, v141
    v_cvt_pk_bf16_f32 v219, v142, v143
    v_cvt_pk_bf16_f32 v220, v144, v145
    v_cvt_pk_bf16_f32 v221, v146, v147
    v_cvt_pk_bf16_f32 v222, v148, v149
    v_cvt_pk_bf16_f32 v223, v150, v151
    s_mov_b64 s[76:77], 0
    s_mov_b32 s78, 0
    s_mov_b32 s5, s59
    s_lshl_b32 s4, s34, 3
    s_add_u32 s4, s4, s35
    s_lshl_b32 s4, s4, 7
    s_lshl_b32 s6, s32, 9
    s_sub_u32 s4, s4, s6
    s_add_u32 s4, s4, 18432
    s_mov_b32 s28, s67
    s_mov_b32 s29, s69
    s_cmp_eq_u32 s3, 2
    s_cbranch_scc1 PT_5
    s_cmp_eq_u32 s3, 3
    s_cbranch_scc1 PT_6
    s_branch PL_3
ZA_15:
    s_mov_b32 s0, 0
    s_atomic_add s0, s[24:25], 22400 glc
    s_branch ZA_15R
ZB_16:
    s_mov_b32 s1, 0
ZC_17:
    s_waitcnt lgkmcnt(0)
    s_cmp_eq_u32 s0, 4
    s_cbranch_scc1 ZD_18
    s_add_u32 s1, s1, 1
    s_cmp_gt_u32 s1, 1048576
    s_cbranch_scc1 ZD_18
    s_mov_b32 s0, 0
    s_atomic_add s0, s[24:25], 22400 glc
    s_branch ZC_17
ZD_18:
    buffer_load_dword v184, v214, s[12:15], s45 offen offset:0 sc1
    buffer_load_dword v185, v214, s[12:15], s45 offen offset:1024 sc1
    buffer_load_dword v186, v214, s[12:15], s45 offen offset:2048 sc1
    buffer_load_dword v187, v214, s[12:15], s45 offen offset:3072 sc1
    s_branch ZB_16R
ZE_19:
    s_waitcnt vmcnt(10)
    v_mfma_f32_32x32x16_bf16 v[16:31], v[184:187], v[188:191], v[16:31]
    s_nop 11
    s_branch ZE_19R
PE_3:
    .p2align 12
PT_3:
    s_branch PL_1
    s_nop 0
PL_3:
    s_and_b32 s69, s35, 1
    s_lshl_b32 s6, s34, 1
    s_or_b32 s69, s69, s6
    s_lshl_b32 s39, s33, 7
    s_lshl_b32 s6, s32, 9
    s_sub_u32 s39, s39, s6
    s_add_u32 s39, s39, 16384
    s_lshl_b32 s7, s32, 2
    s_xor_b32 s6, s69, 0
    s_add_u32 s6, s6, s7
    s_add_u32 m0, s60, 73728
    s_mov_b32 s61, 1035776
    buffer_load_dwordx4 v209, s[16:19], s61 offen lds
    s_mul_i32 s44, s6, 28672
    s_add_u32 s44, s44, 4292608
    s_and_b32 s40, s6, 1
    s_lshr_b32 s6, s6, 1
    s_lshl_b32 s6, s6, 2
    s_add_u32 s6, s6, s3
    s_mul_i32 s6, s6, 14
    s_add_u32 s6, s6, s33
    s_lshl_b32 s6, s6, 1
    buffer_load_dwordx4 v209, s[20:23], s61 offen offset:1024 lds
    s_add_u32 s6, s6, s40
    s_lshl_b32 s6, s6, 11
    s_add_u32 s40, s6, 7962624
    s_xor_b32 s6, s69, 1
    s_add_u32 s6, s6, s7
    s_mul_i32 s45, s6, 28672
    s_add_u32 s45, s45, 4292608
    s_and_b32 s41, s6, 1
    s_lshr_b32 s6, s6, 1
    s_lshl_b32 s6, s6, 2
    s_add_u32 m0, s60, 81920
    s_mov_b32 s61, 573440
    buffer_load_dwordx4 v208, s[16:19], s61 offen lds
    s_add_u32 s6, s6, s3
    s_mul_i32 s6, s6, 14
    s_add_u32 s6, s6, s33
    s_lshl_b32 s6, s6, 1
    s_add_u32 s6, s6, s41
    s_lshl_b32 s6, s6, 11
    s_add_u32 s41, s6, 7962624
    s_xor_b32 s6, s69, 2
    s_add_u32 s6, s6, s7
    buffer_load_dwordx4 v208, s[20:23], s61 offen offset:1024 lds
    s_mul_i32 s46, s6, 28672
    s_add_u32 s46, s46, 4292608
    s_and_b32 s42, s6, 1
    s_lshr_b32 s6, s6, 1
    s_lshl_b32 s6, s6, 2
    s_add_u32 s6, s6, s3
    s_mul_i32 s6, s6, 14
    s_add_u32 s6, s6, s33
    s_lshl_b32 s6, s6, 1
    s_add_u32 s6, s6, s42
    s_add_u32 m0, s60, 90112
    s_mov_b32 s61, 630784
    buffer_load_dwordx4 v208, s[16:19], s61 offen lds
    s_lshl_b32 s6, s6, 11
    s_add_u32 s42, s6, 7962624
    s_xor_b32 s6, s69, 3
    s_add_u32 s6, s6, s7
    s_mul_i32 s47, s6, 28672
    s_add_u32 s47, s47, 4292608
    s_and_b32 s43, s6, 1
    s_lshr_b32 s6, s6, 1
    s_lshl_b32 s6, s6, 2
    buffer_load_dwordx4 v208, s[20:23], s61 offen offset:1024 lds
    s_add_u32 s6, s6, s3
    s_mul_i32 s6, s6, 14
    s_add_u32 s6, s6, s33
    s_lshl_b32 s6, s6, 1
    s_add_u32 s6, s6, s43
    s_lshl_b32 s6, s6, 11
    s_add_u32 s43, s6, 7962624
    s_xor_b32 s6, s69, s3
    s_add_u32 s6, s6, s7
    s_mul_i32 s37, s6, 3584
    s_add_u32 m0, s60, 98304
    s_mov_b32 s61, 978432
    buffer_load_dwordx4 v209, s[16:19], s61 offen lds
    s_add_u32 s37, s37, 2457600
    s_lshl_b32 s6, s33, 2
    s_add_u32 s6, s6, s3
    s_lshl_b32 s38, s6, 10
    s_add_u32 s38, s38, 2326528
    v_lshlrev_b32 v6, 3, v2
    v_add_u32 v7, 59392, v3
    v_add_u32 v8, 118784, v6
    s_mul_i32 s66, s3, 7168
    buffer_load_dwordx4 v209, s[20:23], s61 offen offset:1024 lds
    v_add_u32 v14, s66, v3
    v_add_u32 v15, 4096, v14
    s_xor_b32 s83, s34, 0
    s_xor_b32 s6, s62, 0
    s_add_u32 s70, s7, s6
    s_cmp_eq_u32 s3, 2
    s_cselect_b32 s4, s39, s4
    s_cselect_b32 s39, 2, 28
    s_cmp_eq_u32 s3, 3
    s_cselect_b32 s4, s79, s4
    s_cselect_b32 s39, 7, s39
    s_add_u32 m0, s60, 106496
    s_mov_b32 s61, 921088
    buffer_load_dwordx4 v209, s[16:19], s61 offen lds
    s_lshr_b32 s63, s3, 1
    s_and_b32 s72, s3, 1
    s_lshl_b32 s6, s35, 2
    s_add_u32 s6, s6, s72
    s_mul_i32 s6, s6, 57344
    s_add_u32 s6, s6, 2686976
    v_add_u32 v143, s6, v3
    s_mul_i32 s71, s83, 7
    buffer_load_dwordx4 v209, s[20:23], s61 offen offset:1024 lds
    s_sub_u32 s67, 8, s71
    s_sub_u32 s67, s67, s63
    s_add_u32 s68, s71, s63
    s_lshl_b32 s67, s67, 12
    s_lshl_b32 s68, s68, 12
    s_lshl_b32 s71, s71, 12
    s_cmp_eq_u32 s63, 0
    s_cselect_b32 s71, s71, s67
    s_add_u32 s48, s67, 0
    s_add_u32 s49, s67, 114688
    s_waitcnt vmcnt(10)
    s_barrier
    s_cmp_lg_u32 s3, 2
    s_cbranch_scc1 SIG_22
    s_atomic_add s74, s[30:31], 0
SIG_22:
    s_cmp_lg_u32 s3, 0
    s_cbranch_scc1 MI_23
    s_mov_b32 s76, -1
    s_atomic_and s76, s[30:31], 0 glc
MI_23:
    s_mov_b32 s75, 99
    s_cmp_lg_u32 s29, 1
    s_cbranch_scc1 WS_24
    s_atomic_add s74, s[24:25], s28
    s_atomic_add s74, s[24:25], s28 offset:1024
WS_24:
    s_add_u32 m0, s60, 131072
    s_mov_b32 s61, 688128
    buffer_load_dwordx4 v208, s[16:19], s61 offen lds
    ds_read_b64_tr_b16 a[80:81], v211 offset:0
    ds_read_b64_tr_b16 a[82:83], v211 offset:4096
    ds_read_b64_tr_b16 a[84:85], v211 offset:1024
    ds_read_b64_tr_b16 a[86:87], v211 offset:5120
    buffer_load_dwordx4 v208, s[20:23], s61 offen offset:1024 lds
    ds_read_b64_tr_b16 a[88:89], v211 offset:8192
    ds_read_b64_tr_b16 a[90:91], v211 offset:12288
    ds_read_b64_tr_b16 a[92:93], v211 offset:9216
    ds_read_b64_tr_b16 a[94:95], v211 offset:13312
    s_add_u32 m0, s60, 139264
    s_mov_b32 s61, 745472
    buffer_load_dwordx4 v208, s[16:19], s61 offen lds
    ds_read_b64_tr_b16 a[96:97], v211 offset:16384
    ds_read_b64_tr_b16 a[98:99], v211 offset:20480
    ds_read_b64_tr_b16 a[100:101], v211 offset:17408
    ds_read_b64_tr_b16 a[102:103], v211 offset:21504
    buffer_load_dwordx4 v208, s[20:23], s61 offen offset:1024 lds
    ds_read_b64_tr_b16 a[104:105], v211 offset:24576
    ds_read_b64_tr_b16 a[106:107], v211 offset:28672
    ds_read_b64_tr_b16 a[108:109], v211 offset:25600
    ds_read_b64_tr_b16 a[110:111], v211 offset:29696
    s_add_u32 m0, s60, 147456
    s_mov_b32 s61, 863744
    buffer_load_dwordx4 v209, s[16:19], s61 offen lds
    s_cmp_lg_u32 s3, 0
    s_cbranch_scc1 MI_25
    s_mov_b32 s77, -1
    s_atomic_and s77, s[30:31], 0 glc
MI_25:
    ds_read_b64_tr_b16 a[112:113], v211 offset:32768
    ds_read_b64_tr_b16 a[114:115], v211 offset:36864
    ds_read_b64_tr_b16 a[116:117], v211 offset:33792
    ds_read_b64_tr_b16 a[118:119], v211 offset:37888
    buffer_load_dwordx4 v209, s[20:23], s61 offen offset:1024 lds
    ds_read_b64_tr_b16 a[120:121], v211 offset:40960
    ds_read_b64_tr_b16 a[122:123], v211 offset:45056
    ds_read_b64_tr_b16 a[124:125], v211 offset:41984
    ds_read_b64_tr_b16 a[126:127], v211 offset:46080
    s_add_u32 m0, s60, 155648
    s_mov_b32 s61, 806400
    buffer_load_dwordx4 v209, s[16:19], s61 offen lds
    ds_read_b64_tr_b16 a[128:129], v211 offset:49152
    ds_read_b64_tr_b16 a[130:131], v211 offset:53248
    ds_read_b64_tr_b16 a[132:133], v211 offset:50176
    ds_read_b64_tr_b16 a[134:135], v211 offset:54272
    buffer_load_dwordx4 v209, s[20:23], s61 offen offset:1024 lds
    ds_read_b64_tr_b16 a[136:137], v211 offset:57344
    ds_read_b64_tr_b16 a[138:139], v211 offset:61440
    ds_read_b64_tr_b16 a[140:141], v211 offset:58368
    ds_read_b64_tr_b16 a[142:143], v211 offset:62464
    ds_read_b64_tr_b16 a[144:145], v212 offset:0
    ds_read_b64_tr_b16 a[146:147], v212 offset:4096
    ds_read_b64_tr_b16 a[148:149], v212 offset:1024
    ds_read_b64_tr_b16 a[150:151], v212 offset:5120
    s_mul_i32 s0, s3, 3072
    s_mov_b32 m0, s0
    s_add_u32 s28, s44, s0
    s_lshl_b32 s26, s3, 12
    s_add_u32 s26, s26, 12288
    s_add_u32 s27, s26, s44
    ds_read_b32 v128, v6
    ds_read_b32 v128, v6
    ds_read_b32 v128, v6
    s_waitcnt lgkmcnt(3)
    s_cmp_lg_u32 s3, 0
    s_cbranch_scc1 MD_27
    s_mov_b32 s1, -1
MC_26:
    s_cmp_ge_i32 s76, 7
    s_cbranch_scc1 MD_27
    s_cmp_ge_i32 s77, 7
    s_cbranch_scc1 MD_27
    s_cmp_ge_i32 s78, 7
    s_cbranch_scc1 MD_27
    s_add_u32 s1, s1, 1
    s_cmp_gt_u32 s1, 4194304
    s_cbranch_scc1 MD_27
    s_and_b32 s0, s1, 3
    s_cbranch_scc1 MC_26
    s_cmp_lg_u32 s76, -1
    s_cbranch_scc1 MR_28
    s_cmp_lg_u32 s77, -1
    s_cbranch_scc1 MR_29
    s_cmp_lg_u32 s78, -1
    s_cbranch_scc1 MR_30
    s_branch MC_26
MR_28:
    s_cmp_ge_i32 s76, 7
    s_cbranch_scc1 MD_27
    s_mov_b32 s76, -1
    s_atomic_and s76, s[30:31], 0 glc
    s_branch MC_26
MR_29:
    s_cmp_ge_i32 s77, 7
    s_cbranch_scc1 MD_27
    s_mov_b32 s77, -1
    s_atomic_and s77, s[30:31], 0 glc
    s_branch MC_26
MR_30:
    s_cmp_ge_i32 s78, 7
    s_cbranch_scc1 MD_27
    s_mov_b32 s78, -1
    s_atomic_and s78, s[30:31], 0 glc
    s_branch MC_26
MD_27:
    s_waitcnt vmcnt(8)
    s_barrier
    buffer_load_dwordx4 v3, s[12:15], s28 offen offset:0 sc1 lds
    buffer_load_dwordx4 v3, s[12:15], s28 offen offset:1024 sc1 lds
    buffer_load_dwordx4 v3, s[12:15], s28 offen offset:2048 sc1 lds
    s_mov_b32 m0, s26
    s_nop 0
    buffer_load_dwordx4 v3, s[12:15], s27 offen offset:0 sc1 lds
    ds_read_b64_tr_b16 a[152:153], v212 offset:8192
    ds_read_b64_tr_b16 a[154:155], v212 offset:12288
    ds_read_b64_tr_b16 a[156:157], v212 offset:9216
    ds_read_b64_tr_b16 a[158:159], v212 offset:13312
    buffer_load_dwordx4 v3, s[12:15], s27 offen offset:1024 sc1 lds
    ds_read_b64_tr_b16 a[160:161], v212 offset:16384
    ds_read_b64_tr_b16 a[162:163], v212 offset:20480
    ds_read_b64_tr_b16 a[164:165], v212 offset:17408
    ds_read_b64_tr_b16 a[166:167], v212 offset:21504
    buffer_load_dwordx4 v3, s[12:15], s27 offen offset:2048 sc1 lds
    ds_read_b64_tr_b16 a[168:169], v212 offset:24576
    ds_read_b64_tr_b16 a[170:171], v212 offset:28672
    ds_read_b64_tr_b16 a[172:173], v212 offset:25600
    ds_read_b64_tr_b16 a[174:175], v212 offset:29696
    buffer_load_dwordx4 v3, s[12:15], s27 offen offset:3072 sc1 lds
    ds_read_b64_tr_b16 a[176:177], v212 offset:32768
    ds_read_b64_tr_b16 a[178:179], v212 offset:36864
    ds_read_b64_tr_b16 a[180:181], v212 offset:33792
    ds_read_b64_tr_b16 a[182:183], v212 offset:37888
    s_add_u32 m0, s66, 29696
    s_nop 0
    buffer_load_dwordx4 v14, s[12:15], s45 offen offset:0 sc1 lds
    ds_read_b64_tr_b16 a[184:185], v212 offset:40960
    ds_read_b64_tr_b16 a[186:187], v212 offset:45056
    ds_read_b64_tr_b16 a[188:189], v212 offset:41984
    ds_read_b64_tr_b16 a[190:191], v212 offset:46080
    buffer_load_dwordx4 v14, s[12:15], s45 offen offset:1024 sc1 lds
    s_cmp_lt_u32 s3, 1
    s_cbranch_scc1 XP_31
    s_mov_b32 s75, -1
    s_atomic_and s75, s[24:25], s4 glc
XP_31:
    s_add_u32 s50, s68, 0
    s_add_u32 s51, s68, 114688
    s_add_u32 s52, s67, 8192
    s_add_u32 s53, s67, 122880
    s_add_u32 s54, s68, 8192
    s_add_u32 s55, s68, 122880
    s_add_u32 s56, s67, 16384
    s_add_u32 s57, s67, 131072
    s_add_u32 s58, s68, 16384
    s_add_u32 s59, s68, 131072
    s_add_u32 s64, s71, 24576
    s_add_u32 s65, s71, 139264
    s_lshl_b32 s6, s32, 1
    s_add_u32 s6, s6, s83
    s_lshl_b32 s6, s6, 2
    s_add_u32 s6, s6, s72
    s_mul_i32 s6, s6, 57344
    s_add_u32 s6, s6, 7962624
    s_lshl_b32 s67, s63, 11
    s_add_u32 s6, s6, s67
    s_lshl_b32 s67, s72, 8
    s_add_u32 s6, s6, s67
    v_and_b32 v4, 15, v2
    v_lshlrev_b32 v127, 4, v4
    v_lshrrev_b32 v108, 4, v2
    v_lshl_add_u32 v127, v108, 9, v127
    v_add_u32 v9, s6, v127
    v_xor_b32 v142, 2048, v9
    s_lshl_b32 s73, s3, 12
    v_add_u32 v10, s73, v3
    v_add_u32 v11, 120832, v10
    s_mul_i32 s70, s70, 28672
    s_add_u32 s70, s70, s67
    s_add_u32 s70, s70, 6127616
    s_lshl_b32 s6, s35, 2
    s_sub_u32 s7, 29, s6
    s_add_u32 s68, s6, 2
    s_sub_u32 s69, s7, 2
    s_cmp_le_u32 s35, 2
    s_cselect_b32 s68, s68, s69
    s_sub_u32 s67, s7, 4
    s_cmp_le_u32 s35, 3
    s_cselect_b32 s67, s6, s67
    s_cselect_b32 s69, 1, s7
    s_cmp_eq_u32 s35, 3
    s_cselect_b32 s68, 13, s68
    v_add_u32 v127, s70, v127
    s_mul_i32 s71, s3, 3072
    s_add_u32 s71, s71, 59392
    s_lshl_b32 s6, s35, 6
    s_add_u32 s6, s6, 0
    v_lshl_add_u32 v104, v4, 2, s6
    v_cmp_le_u32 vcc, 224, v104
    v_sub_u32 v105, 448, v104
    s_nop 0
    v_cndmask_b32 v105, v104, v105, vcc
    v_cndmask_b32 v106, 0, 1, vcc
    v_cmp_eq_u32 vcc, 224, v105
    s_nop 1
    v_cndmask_b32 v105, v105, 0, vcc
    v_lshrrev_b32 v107, 5, v105
    v_lshl_add_u32 v107, v107, 1, v106
    v_cmp_eq_u32 vcc, s68, v107
    v_mov_b32 v106, 2
    s_branch PL_4
PE_4:
    .p2align 12
PT_4:
    s_branch PL_1
    s_nop 0
PL_4:
    s_waitcnt vmcnt(6)
    s_barrier
    ds_read_b128 v[80:83], v3 offset:0
    ds_read_b128 v[84:87], v3 offset:1024
    ds_read_b128 v[88:91], v3 offset:2048
    ds_read_b128 v[92:95], v3 offset:3072
    s_waitcnt lgkmcnt(3)
    v_mfma_f32_32x32x16_bf16 v[16:31], a[0:3], v[80:83], 0
    ds_read_b64_tr_b16 a[192:193], v213 offset:0
    buffer_load_dwordx4 v14, s[12:15], s45 offen offset:2048 sc1 lds
    v_mfma_f32_32x32x16_bf16 v[32:47], a[4:7], v[80:83], 0
    ds_read_b64_tr_b16 a[194:195], v213 offset:4096
    ds_read_b128 v[80:83], v3 offset:4096
    s_waitcnt lgkmcnt(5)
    v_mfma_f32_32x32x16_bf16 v[16:31], a[8:11], v[84:87], v[16:31]
    ds_read_b64_tr_b16 a[196:197], v213 offset:1024
    buffer_load_dwordx4 v14, s[12:15], s45 offen offset:3072 sc1 lds
    v_mfma_f32_32x32x16_bf16 v[32:47], a[12:15], v[84:87], v[32:47]
    ds_read_b64_tr_b16 a[198:199], v213 offset:5120
    ds_read_b128 v[84:87], v3 offset:5120
    s_waitcnt lgkmcnt(7)
    v_mfma_f32_32x32x16_bf16 v[16:31], a[16:19], v[88:91], v[16:31]
    ds_read_b64_tr_b16 a[200:201], v213 offset:8192
    s_add_u32 m0, s66, 33792
    s_nop 0
    buffer_load_dwordx4 v15, s[12:15], s45 offen offset:0 sc1 lds
    v_mfma_f32_32x32x16_bf16 v[32:47], a[20:23], v[88:91], v[32:47]
    ds_read_b64_tr_b16 a[202:203], v213 offset:12288
    ds_read_b128 v[88:91], v3 offset:6144
    s_waitcnt lgkmcnt(9)
    v_mfma_f32_32x32x16_bf16 v[16:31], a[24:27], v[92:95], v[16:31]
    ds_read_b64_tr_b16 a[204:205], v213 offset:9216
    buffer_load_dwordx4 v15, s[12:15], s45 offen offset:1024 sc1 lds
    v_mfma_f32_32x32x16_bf16 v[32:47], a[28:31], v[92:95], v[32:47]
    ds_read_b64_tr_b16 a[206:207], v213 offset:13312
    ds_read_b128 v[92:95], v3 offset:7168
    s_waitcnt lgkmcnt(9)
    v_mfma_f32_32x32x16_bf16 v[16:31], a[32:35], v[80:83], v[16:31]
    ds_read_b64_tr_b16 a[208:209], v213 offset:16384
    buffer_load_dwordx4 v15, s[12:15], s45 offen offset:2048 sc1 lds
    v_mfma_f32_32x32x16_bf16 v[32:47], a[36:39], v[80:83], v[32:47]
    ds_read_b64_tr_b16 a[210:211], v213 offset:20480
    ds_read_b128 v[80:83], v3 offset:8192
    s_waitcnt lgkmcnt(9)
    v_mfma_f32_32x32x16_bf16 v[16:31], a[40:43], v[84:87], v[16:31]
    ds_read_b64_tr_b16 a[212:213], v213 offset:17408
    buffer_store_dwordx4 v[216:219], v3, s[12:15], s5 offen offset:0 sc1
    v_mfma_f32_32x32x16_bf16 v[32:47], a[44:47], v[84:87], v[32:47]
    ds_read_b64_tr_b16 a[214:215], v213 offset:21504
    ds_read_b128 v[84:87], v3 offset:9216
    s_waitcnt lgkmcnt(9)
    v_mfma_f32_32x32x16_bf16 v[16:31], a[48:51], v[88:91], v[16:31]
    ds_read_b64_tr_b16 a[216:217], v213 offset:24576
    buffer_store_dwordx4 v[220:223], v3, s[12:15], s5 offen offset:1024 sc1
    v_mfma_f32_32x32x16_bf16 v[32:47], a[52:55], v[88:91], v[32:47]
    ds_read_b64_tr_b16 a[218:219], v213 offset:28672
    ds_read_b128 v[88:91], v3 offset:10240
    s_waitcnt lgkmcnt(9)
    v_mfma_f32_32x32x16_bf16 v[16:31], a[56:59], v[92:95], v[16:31]
    ds_read_b64_tr_b16 a[220:221], v213 offset:25600
    v_mfma_f32_32x32x16_bf16 v[32:47], a[60:63], v[92:95], v[32:47]
    ds_read_b64_tr_b16 a[222:223], v213 offset:29696
    ds_read_b128 v[92:95], v3 offset:11264
    s_waitcnt lgkmcnt(9)
    v_mfma_f32_32x32x16_bf16 v[16:31], a[64:67], v[80:83], v[16:31]
    v_mfma_f32_32x32x16_bf16 v[32:47], a[68:71], v[80:83], v[32:47]
    s_cmp_ge_i32 s75, s39
    s_cbranch_scc1 XD_33
    s_mov_b32 s1, 0
XC_32:
    s_waitcnt lgkmcnt(0)
    s_cmp_ge_i32 s75, s39
    s_cbranch_scc1 XD_33
    s_add_u32 s1, s1, 1
    s_cmp_gt_u32 s1, 1048576
    s_cbranch_scc1 XD_33
    s_mov_b32 s75, -1
    s_atomic_and s75, s[24:25], s4 glc
    s_branch XC_32
XD_33:
    s_waitcnt vmcnt(9)
    s_barrier
    ds_read_b128 v[80:83], v3 offset:12288
    s_waitcnt lgkmcnt(7)
    v_mfma_f32_32x32x16_bf16 v[16:31], a[72:75], v[84:87], v[16:31]
    buffer_load_dwordx4 v[128:131], v3, s[12:15], s37 offen offset:0 sc1
    v_mfma_f32_32x32x16_bf16 v[32:47], a[76:79], v[84:87], v[32:47]
    ds_read_b128 v[84:87], v3 offset:13312
    s_waitcnt lgkmcnt(5)
    v_mfma_f32_32x32x16_bf16 v[16:31], a[80:83], v[88:91], v[16:31]
    buffer_load_dwordx4 v[132:135], v3, s[12:15], s37 offen offset:1024 sc1
    v_mfma_f32_32x32x16_bf16 v[32:47], a[84:87], v[88:91], v[32:47]
    ds_read_b128 v[88:91], v3 offset:14336
    s_waitcnt lgkmcnt(3)
    v_mfma_f32_32x32x16_bf16 v[16:31], a[88:91], v[92:95], v[16:31]
    buffer_load_dwordx4 v[136:139], v3, s[12:15], s37 offen offset:2048 sc1
    v_mfma_f32_32x32x16_bf16 v[32:47], a[92:95], v[92:95], v[32:47]
    ds_read_b128 v[92:95], v3 offset:15360
    s_waitcnt lgkmcnt(3)
    v_mfma_f32_32x32x16_bf16 v[16:31], a[96:99], v[80:83], v[16:31]
    v_mov_b64 v[112:113], 0
    v_mov_b64 v[114:115], 0
    s_mov_b32 exec_hi, 0
    buffer_load_dwordx4 v[112:115], v3, s[12:15], s37 offen offset:3072 sc1
    s_mov_b32 exec_hi, -1
    v_cndmask_b32 v106, v106, 1, vcc
    v_cmp_eq_u32 vcc, s67, v107
    v_bfe_u32 v107, v105, 4, 1
    s_nop 0
    v_cndmask_b32 v106, v106, 0, vcc
    v_lshlrev_b32 v106, 10, v106
    v_mfma_f32_32x32x16_bf16 v[32:47], a[100:103], v[80:83], v[32:47]
    v_lshl_add_u32 v106, v107, 9, v106
    v_bfe_u32 v107, v105, 2, 1
    v_lshl_add_u32 v106, v107, 8, v106
    v_bfe_u32 v107, v105, 3, 1
    ds_read_b128 v[80:83], v3 offset:16384
    s_waitcnt lgkmcnt(3)
    v_mfma_f32_32x32x16_bf16 v[16:31], a[104:107], v[84:87], v[16:31]
    s_add_u32 m0, s66, 59392
    s_nop 0
    buffer_load_dwordx4 v14, s[12:15], s46 offen offset:0 sc1 lds
    v_lshl_add_u32 v106, v107, 3, v106
    v_and_b32 v107, 3, v105
    v_lshl_add_u32 v106, v107, 1, v106
    v_lshl_add_u32 v106, v108, 6, v106
    v_mfma_f32_32x32x16_bf16 v[32:47], a[108:111], v[84:87], v[32:47]
    v_add_u32 v12, s71, v106
    s_lshl_b32 s6, s35, 6
    s_add_u32 s6, s6, 1
    v_lshl_add_u32 v104, v4, 2, s6
    ds_read_b128 v[84:87], v3 offset:17408
    s_waitcnt lgkmcnt(3)
    v_mfma_f32_32x32x16_bf16 v[16:31], a[112:115], v[88:91], v[16:31]
    buffer_load_dwordx4 v14, s[12:15], s46 offen offset:1024 sc1 lds
    v_cmp_le_u32 vcc, 224, v104
    v_sub_u32 v105, 448, v104
    s_nop 0
    v_cndmask_b32 v105, v104, v105, vcc
    v_cndmask_b32 v106, 0, 1, vcc
    v_mfma_f32_32x32x16_bf16 v[32:47], a[116:119], v[88:91], v[32:47]
    v_cmp_eq_u32 vcc, 224, v105
    s_nop 1
    v_cndmask_b32 v105, v105, 0, vcc
    v_lshrrev_b32 v107, 5, v105
    v_lshl_add_u32 v107, v107, 1, v106
    ds_read_b128 v[88:91], v3 offset:18432
    s_waitcnt lgkmcnt(3)
    v_mfma_f32_32x32x16_bf16 v[16:31], a[120:123], v[92:95], v[16:31]
    buffer_load_dwordx4 v14, s[12:15], s46 offen offset:2048 sc1 lds
    v_cmp_eq_u32 vcc, s68, v107
    v_mov_b32 v106, 2
    s_nop 0
    v_cndmask_b32 v106, v106, 1, vcc
    v_cmp_eq_u32 vcc, s67, v107
    v_mfma_f32_32x32x16_bf16 v[32:47], a[124:127], v[92:95], v[32:47]
    v_bfe_u32 v107, v105, 4, 1
    v_cndmask_b32 v106, v106, 0, vcc
    v_lshlrev_b32 v106, 10, v106
    v_lshl_add_u32 v106, v107, 9, v106
    ds_read_b128 v[92:95], v3 offset:19456
    s_waitcnt lgkmcnt(3)
    v_mfma_f32_32x32x16_bf16 v[16:31], a[128:131], v[80:83], v[16:31]
    buffer_load_dwordx4 v14, s[12:15], s46 offen offset:3072 sc1 lds
    v_bfe_u32 v107, v105, 2, 1
    v_lshl_add_u32 v106, v107, 8, v106
    v_bfe_u32 v107, v105, 3, 1
    v_lshl_add_u32 v106, v107, 3, v106
    v_mfma_f32_32x32x16_bf16 v[32:47], a[132:135], v[80:83], v[32:47]
    v_and_b32 v107, 3, v105
    v_lshl_add_u32 v106, v107, 1, v106
    v_lshl_add_u32 v106, v108, 6, v106
    v_add_u32 v13, s71, v106
    ds_read_b128 v[80:83], v3 offset:20480
    s_waitcnt lgkmcnt(3)
    v_mfma_f32_32x32x16_bf16 v[16:31], a[136:139], v[84:87], v[16:31]
    s_add_u32 m0, s66, 63488
    s_nop 0
    buffer_load_dwordx4 v15, s[12:15], s46 offen offset:0 sc1 lds
    s_lshl_b32 s67, s67, 11
    s_lshl_b32 s68, s68, 11
    s_lshl_b32 s69, s69, 11
    s_xor_b32 s6, s3, 1
    v_mfma_f32_32x32x16_bf16 v[32:47], a[140:143], v[84:87], v[32:47]
    s_mul_i32 s6, s6, 12288
    s_add_u32 s6, s6, 71680
    v_add_u32 v124, s6, v3
    s_xor_b32 s6, s3, 2
    ds_read_b128 v[84:87], v3 offset:21504
    s_waitcnt lgkmcnt(3)
    v_mfma_f32_32x32x16_bf16 v[16:31], a[144:147], v[88:91], v[16:31]
    buffer_load_dwordx4 v15, s[12:15], s46 offen offset:1024 sc1 lds
    s_mul_i32 s6, s6, 12288
    s_add_u32 s6, s6, 75776
    v_add_u32 v125, s6, v3
    s_xor_b32 s6, s3, 3
    v_mfma_f32_32x32x16_bf16 v[32:47], a[148:151], v[88:91], v[32:47]
    s_mul_i32 s6, s6, 12288
    s_add_u32 s6, s6, 79872
    v_add_u32 v126, s6, v3
    s_mul_i32 s6, s3, 12288
    ds_read_b128 v[88:91], v3 offset:22528
    s_waitcnt lgkmcnt(3)
    v_mfma_f32_32x32x16_bf16 v[16:31], a[152:155], v[92:95], v[16:31]
    buffer_load_dwordx4 v15, s[12:15], s46 offen offset:2048 sc1 lds
    s_add_u32 s6, s6, 71680
    v_add_u32 v1, s6, v3
    s_sub_u32 s6, 64, s36
    s_cmp_eq_u32 s36, 0
    s_cselect_b32 s6, 32, s6
    s_cmp_eq_u32 s63, 0
    s_cselect_b32 s7, s36, s6
    v_mfma_f32_32x32x16_bf16 v[32:47], a[156:159], v[92:95], v[32:47]
    s_lshl_b32 s72, s72, 10
    ds_read_b128 v[92:95], v3 offset:23552
    s_waitcnt lgkmcnt(3)
    v_mfma_f32_32x32x16_bf16 v[16:31], a[160:163], v[80:83], v[16:31]
    buffer_load_dwordx4 v[96:99], v3, s[12:15], s38 offen sc1
    s_add_u32 s72, s72, s7
    s_mul_i32 s72, s72, 896
    s_lshl_b32 s6, s35, 7
    s_add_u32 s72, s72, s6
    v_mfma_f32_32x32x16_bf16 v[32:47], a[164:167], v[80:83], v[32:47]
    v_mul_u32_u24 v0, 229376, v108
    v_lshl_add_u32 v0, v4, 3, v0
    s_mov_b32 s8, s80
    s_and_b32 s9, s81, 0xffff
    ds_read_b128 v[80:83], v3 offset:24576
    s_waitcnt lgkmcnt(3)
    v_mfma_f32_32x32x16_bf16 v[16:31], a[168:171], v[84:87], v[16:31]
    buffer_load_dwordx4 v[144:147], v143, s[12:15], s48 offen offset:0 sc1
    v_lshlrev_b32 v2, 7, v2
    s_bitcmp1_b32 s3, 0
    s_cselect_b32 s6, 0xffffff00, 0
    s_cselect_b32 s7, -1, 0
    s_cselect_b32 s6, s6, 0x100
    s_add_u32 s16, s12, s6
    s_addc_u32 s17, s13, s7
    s_mov_b32 s18, 15302912
    v_mfma_f32_32x32x16_bf16 v[32:47], a[172:175], v[84:87], v[32:47]
    ds_read_b128 v[84:87], v3 offset:25600
    s_waitcnt lgkmcnt(3)
    v_mfma_f32_32x32x16_bf16 v[16:31], a[176:179], v[88:91], v[16:31]
    buffer_load_dwordx4 v[148:151], v143, s[12:15], s48 offen offset:1024 sc1
    v_mfma_f32_32x32x16_bf16 v[32:47], a[180:183], v[88:91], v[32:47]
    ds_read_b128 v[88:91], v3 offset:26624
    s_waitcnt lgkmcnt(3)
    v_mfma_f32_32x32x16_bf16 v[16:31], a[184:187], v[92:95], v[16:31]
    buffer_load_dwordx4 v[152:155], v143, s[12:15], s48 offen offset:2048 sc1
    v_mfma_f32_32x32x16_bf16 v[32:47], a[188:191], v[92:95], v[32:47]
    ds_read_b128 v[92:95], v3 offset:27648
    s_waitcnt lgkmcnt(3)
    v_mfma_f32_32x32x16_bf16 v[16:31], a[192:195], v[80:83], v[16:31]
    buffer_load_dwordx4 v[156:159], v143, s[12:15], s48 offen offset:3072 sc1
    v_mfma_f32_32x32x16_bf16 v[32:47], a[196:199], v[80:83], v[32:47]
    s_waitcnt vmcnt(18)
    s_barrier
    ds_read_b128 v[80:83], v3 offset:29696
    s_waitcnt vmcnt(12)
    s_waitcnt lgkmcnt(3)
    v_mfma_f32_32x32x16_bf16 v[16:31], a[200:203], v[84:87], v[16:31]
    buffer_load_dwordx4 v[160:163], v143, s[12:15], s49 offen offset:0 sc1
    v_add_f32 v128, v128, v132
    v_add_f32 v136, v136, v112
    v_add_f32 v129, v129, v133
    v_add_f32 v137, v137, v113
    v_add_f32 v130, v130, v134
    v_add_f32 v138, v138, v114
    v_mfma_f32_32x32x16_bf16 v[32:47], a[204:207], v[84:87], v[32:47]
    v_add_f32 v131, v131, v135
    v_add_f32 v139, v139, v115
    v_add_f32 v128, v128, v136
    v_add_f32 v129, v129, v137
    v_add_f32 v130, v130, v138
    v_add_f32 v131, v131, v139
    ds_read_b128 v[84:87], v3 offset:30720
    s_waitcnt lgkmcnt(3)
    v_mfma_f32_32x32x16_bf16 v[16:31], a[208:211], v[88:91], v[16:31]
    buffer_load_dwordx4 v[164:167], v143, s[12:15], s49 offen offset:1024 sc1
    v_lshlrev_b32 v139, 1, v4
    v_bfe_u32 v140, v3, 8, 1
    v_permlane16_swap_b32 v128, v130
    v_permlane16_swap_b32 v129, v131
    v_add_f32 v128, v128, v130
    v_add_f32 v129, v129, v131
    v_mfma_f32_32x32x16_bf16 v[32:47], a[212:215], v[88:91], v[32:47]
    v_add_u32 v139, v139, v140
    v_lshl_add_u32 v139, v5, 5, v139
    v_mov_b32 v130, v128
    v_mov_b32 v131, v129
    s_mul_i32 s6, s3, 29696
    v_lshl_add_u32 v138, v139, 4, s6
    ds_read_b128 v[88:91], v3 offset:31744
    s_waitcnt lgkmcnt(3)
    v_mfma_f32_32x32x16_bf16 v[16:31], a[216:219], v[92:95], v[16:31]
    buffer_load_dwordx4 v[168:171], v143, s[12:15], s49 offen offset:2048 sc1
    v_permlane32_swap_b32 v128, v130
    v_permlane32_swap_b32 v129, v131
    v_add_f32 v128, v128, v130
    v_add_f32 v129, v129, v131
    v_mul_f32 v128, 0xbb124925, v128
    v_mul_f32 v129, 0x3b124925, v129
    v_mfma_f32_32x32x16_bf16 v[32:47], a[220:223], v[92:95], v[32:47]
    v_fma_f32 v129, -v128, v128, v129
    v_max_f32 v129, 0, v129
    v_add_f32 v129, 0x3727c5ac, v129
    v_rsq_f32 v130, v129
    v_sqrt_f32 v131, v129
    ds_read_b128 v[92:95], v3 offset:32768
    s_waitcnt lgkmcnt(3)
    v_mfma_f32_32x32x16_bf16 v[48:63], a[0:3], v[80:83], 0
    buffer_load_dwordx4 v[172:175], v143, s[12:15], s49 offen offset:3072 sc1
    v_cvt_pk_bf16_f32 v132, v128, v128
    v_mul_f32 v130, 0xbfb8aa3b, v130
    v_cvt_pk_bf16_f32 v136, v131, v131
    v_and_b32 v137, 0xffff0000, v132
    v_and_b32 v136, 0xffff0000, v136
    v_mfma_f32_32x32x16_bf16 v[64:79], a[4:7], v[80:83], 0
    v_sub_f32 v137, v128, v137
    v_sub_f32 v136, v131, v136
    v_cmp_eq_u32 vcc, 0, v5
    v_cvt_pk_bf16_f32 v133, v137, v131
    v_cvt_pk_bf16_f32 v134, v131, v136
    v_mov_b32 v135, 0
    ds_read_b128 v[80:83], v3 offset:33792
    s_waitcnt lgkmcnt(3)
    v_mfma_f32_32x32x16_bf16 v[48:63], a[8:11], v[84:87], v[48:63]
    buffer_load_dwordx4 v[176:179], v143, s[12:15], s52 offen offset:0 sc1
    v_cndmask_b32 v132, 0, v132, vcc
    v_cndmask_b32 v133, 0, v133, vcc
    v_cndmask_b32 v134, 0, v134, vcc
    s_lshl_b32 s6, s3, 9
    s_add_u32 s6, s6, 118784
    v_lshl_add_u32 v137, v139, 3, s6
    v_mfma_f32_32x32x16_bf16 v[64:79], a[12:15], v[84:87], v[64:79]
    ds_write_b128 v138, v[132:135] offset:28672
    ds_write_b64 v137, v[130:131]
    ds_read_b128 v[84:87], v3 offset:34816
    s_waitcnt lgkmcnt(5)
    v_mfma_f32_32x32x16_bf16 v[48:63], a[16:19], v[88:91], v[48:63]
    buffer_load_dwordx4 v[180:183], v143, s[12:15], s52 offen offset:1024 sc1
    v_mfma_f32_32x32x16_bf16 v[64:79], a[20:23], v[88:91], v[64:79]
    s_waitcnt vmcnt(11) lgkmcnt(1)
    s_barrier
    ds_read_b64 v[104:105], v8
    s_waitcnt vmcnt(10)
    ds_read_b128 v[88:91], v3 offset:28672
    v_mfma_f32_32x32x16_bf16 v[48:63], a[24:27], v[92:95], v[48:63]
    buffer_load_dwordx4 v[184:187], v143, s[12:15], s52 offen offset:2048 sc1
    v_mov_b64 v[100:101], v[96:97]
    v_mov_b64 v[102:103], v[98:99]
    v_mfma_f32_32x32x16_bf16 v[64:79], a[28:31], v[92:95], v[64:79]
    v_permlane32_swap_b32 v96, v100
    v_permlane32_swap_b32 v97, v101
    ds_read_b128 v[92:95], v3 offset:35840
    v_mfma_f32_32x32x16_bf16 v[48:63], a[32:35], v[80:83], v[48:63]
    buffer_load_dwordx4 v[188:191], v143, s[12:15], s52 offen offset:3072 sc1
    v_permlane32_swap_b32 v98, v102
    v_mfma_f32_32x32x16_bf16 v[64:79], a[36:39], v[80:83], v[64:79]
    ds_read_b128 v[80:83], v3 offset:36864
    s_waitcnt lgkmcnt(4)
    v_mfma_f32_32x32x16_bf16 v[48:63], a[40:43], v[84:87], v[48:63]
    buffer_load_dwordx4 v[192:195], v143, s[12:15], s53 offen offset:0 sc1
    v_mfma_f32_32x32x16_bf16 v[64:79], a[44:47], v[84:87], v[64:79]
    ds_read_b128 v[84:87], v3 offset:37888
    s_waitcnt lgkmcnt(3)
    v_mfma_f32_32x32x16_bf16 v[16:31], v[96:99], v[88:91], v[16:31]
    v_mfma_f32_32x32x16_bf16 v[32:47], v[100:103], v[88:91], v[32:47]
    ds_read_b128 v[88:91], v3 offset:38912
    s_waitcnt lgkmcnt(3)
    v_mfma_f32_32x32x16_bf16 v[48:63], a[48:51], v[92:95], v[48:63]
    s_add_u32 m0, s66, 89088
    s_nop 0
    buffer_load_dwordx4 v14, s[12:15], s47 offen offset:0 sc1 lds
    v_mfma_f32_32x32x16_bf16 v[64:79], a[52:55], v[92:95], v[64:79]
    ds_read_b128 v[92:95], v3 offset:39936
    s_waitcnt lgkmcnt(3)
    v_mfma_f32_32x32x16_bf16 v[48:63], a[56:59], v[80:83], v[48:63]
    buffer_load_dwordx4 v14, s[12:15], s47 offen offset:1024 sc1 lds
    v_mfma_f32_32x32x16_bf16 v[64:79], a[60:63], v[80:83], v[64:79]
    ds_read_b128 v[80:83], v3 offset:40960
    s_waitcnt lgkmcnt(3)
    v_mfma_f32_32x32x16_bf16 v[48:63], a[64:67], v[84:87], v[48:63]
    buffer_load_dwordx4 v14, s[12:15], s47 offen offset:2048 sc1 lds
    v_mul_f32 v108, v16, v104
    v_mul_f32 v109, v17, v104
    v_mul_f32 v110, v18, v104
    v_mul_f32 v111, v19, v104
    v_mfma_f32_32x32x16_bf16 v[64:79], a[68:71], v[84:87], v[64:79]
    v_exp_f32 v108, v108
    v_exp_f32 v109, v109
    ds_read_b128 v[84:87], v3 offset:41984
    s_waitcnt lgkmcnt(3)
    v_mfma_f32_32x32x16_bf16 v[48:63], a[72:75], v[88:91], v[48:63]
    buffer_load_dwordx4 v14, s[12:15], s47 offen offset:3072 sc1 lds
    v_exp_f32 v110, v110
    v_exp_f32 v111, v111
    v_mfma_f32_32x32x16_bf16 v[64:79], a[76:79], v[88:91], v[64:79]
    v_mul_f32 v112, v20, v104
    v_mul_f32 v113, v21, v104
    v_mul_f32 v114, v22, v104
    v_mul_f32 v115, v23, v104
    ds_read_b128 v[88:91], v3 offset:43008
    s_waitcnt lgkmcnt(3)
    v_mfma_f32_32x32x16_bf16 v[48:63], a[80:83], v[92:95], v[48:63]
    s_add_u32 m0, s66, 93184
    s_nop 0
    buffer_load_dwordx4 v15, s[12:15], s47 offen offset:0 sc1 lds
    v_fma_f32 v108, v108, v105, v105
    v_exp_f32 v112, v112
    v_mfma_f32_32x32x16_bf16 v[64:79], a[84:87], v[92:95], v[64:79]
    v_exp_f32 v113, v113
    v_exp_f32 v114, v114
    ds_read_b128 v[92:95], v3 offset:44032
    s_waitcnt lgkmcnt(3)
    v_mfma_f32_32x32x16_bf16 v[48:63], a[88:91], v[80:83], v[48:63]
    buffer_load_dwordx4 v15, s[12:15], s47 offen offset:1024 sc1 lds
    v_exp_f32 v115, v115
    v_fma_f32 v109, v109, v105, v105
    v_fma_f32 v110, v110, v105, v105
    v_mfma_f32_32x32x16_bf16 v[64:79], a[92:95], v[80:83], v[64:79]
    v_fma_f32 v111, v111, v105, v105
    v_fma_f32 v112, v112, v105, v105
    v_rcp_f32 v108, v108
    ds_read_b128 v[80:83], v3 offset:45056
    s_waitcnt lgkmcnt(3)
    v_mfma_f32_32x32x16_bf16 v[48:63], a[96:99], v[84:87], v[48:63]
    buffer_load_dwordx4 v15, s[12:15], s47 offen offset:2048 sc1 lds
    v_rcp_f32 v109, v109
    v_rcp_f32 v110, v110
    v_mfma_f32_32x32x16_bf16 v[64:79], a[100:103], v[84:87], v[64:79]
    v_rcp_f32 v111, v111
    v_fma_f32 v113, v113, v105, v105
    v_fma_f32 v114, v114, v105, v105
    ds_read_b128 v[84:87], v3 offset:46080
    s_waitcnt lgkmcnt(3)
    v_mfma_f32_32x32x16_bf16 v[48:63], a[104:107], v[88:91], v[48:63]
    s_add_u32 m0, s73, 120832
    s_nop 0
    buffer_load_dwordx4 v143, s[12:15], s51 offen offset:0 sc1 lds
    v_fma_f32 v115, v115, v105, v105
    v_rcp_f32 v112, v112
    v_mfma_f32_32x32x16_bf16 v[64:79], a[108:111], v[88:91], v[64:79]
    v_rcp_f32 v113, v113
    v_rcp_f32 v114, v114
    ds_read_b128 v[88:91], v3 offset:47104
    s_waitcnt lgkmcnt(3)
    v_mfma_f32_32x32x16_bf16 v[48:63], a[112:115], v[92:95], v[48:63]
    buffer_load_dwordx4 v143, s[12:15], s51 offen offset:1024 sc1 lds
    v_rcp_f32 v115, v115
    v_mul_f32 v108, v108, v32
    v_mul_f32 v109, v109, v33
    v_mfma_f32_32x32x16_bf16 v[64:79], a[116:119], v[92:95], v[64:79]
    v_mul_f32 v110, v110, v34
    v_mul_f32 v111, v111, v35
    v_mul_f32 v112, v112, v36
    v_cvt_pk_bf16_f32 v116, v108, v109
    ds_read_b128 v[92:95], v3 offset:48128
    s_waitcnt lgkmcnt(3)
    v_mfma_f32_32x32x16_bf16 v[48:63], a[120:123], v[80:83], v[48:63]
    buffer_load_dwordx4 v143, s[12:15], s51 offen offset:2048 sc1 lds
    v_mul_f32 v113, v113, v37
    v_cvt_pk_bf16_f32 v117, v110, v111
    v_mul_f32 v114, v114, v38
    v_mul_f32 v108, v24, v104
    v_mfma_f32_32x32x16_bf16 v[64:79], a[124:127], v[80:83], v[64:79]
    v_mul_f32 v115, v115, v39
    v_mul_f32 v109, v25, v104
    v_cvt_pk_bf16_f32 v118, v112, v113
    v_mul_f32 v110, v26, v104
    ds_read_b128 v[80:83], v3 offset:49152
    s_waitcnt lgkmcnt(3)
    v_mfma_f32_32x32x16_bf16 v[48:63], a[128:131], v[84:87], v[48:63]
    buffer_load_dwordx4 v143, s[12:15], s51 offen offset:3072 sc1 lds
    v_cvt_pk_bf16_f32 v119, v114, v115
    buffer_store_dwordx4 v[116:119], v3, s[12:15], s40 offen offset:0 sc1
    v_mul_f32 v111, v27, v104
    v_mfma_f32_32x32x16_bf16 v[64:79], a[132:135], v[84:87], v[64:79]
    v_exp_f32 v108, v108
    v_exp_f32 v109, v109
    ds_read_b128 v[84:87], v3 offset:50176
    s_waitcnt lgkmcnt(3)
    v_mfma_f32_32x32x16_bf16 v[48:63], a[136:139], v[88:91], v[48:63]
    s_add_u32 m0, s73, 137216
    s_nop 0
    buffer_load_dwordx4 v143, s[12:15], s54 offen offset:0 sc1 lds
    v_mul_f32 v112, v28, v104
    v_exp_f32 v110, v110
    v_mfma_f32_32x32x16_bf16 v[64:79], a[140:143], v[88:91], v[64:79]
    v_exp_f32 v111, v111
    v_mul_f32 v113, v29, v104
    v_mul_f32 v114, v30, v104
    ds_read_b128 v[88:91], v3 offset:51200
    s_waitcnt lgkmcnt(3)
    v_mfma_f32_32x32x16_bf16 v[48:63], a[144:147], v[92:95], v[48:63]
    buffer_load_dwordx4 v143, s[12:15], s54 offen offset:1024 sc1 lds
    v_mul_f32 v115, v31, v104
    v_fma_f32 v108, v108, v105, v105
    v_exp_f32 v112, v112
    v_mfma_f32_32x32x16_bf16 v[64:79], a[148:151], v[92:95], v[64:79]
    v_exp_f32 v113, v113
    v_exp_f32 v114, v114
    ds_read_b128 v[92:95], v3 offset:52224
    s_waitcnt lgkmcnt(3)
    v_mfma_f32_32x32x16_bf16 v[48:63], a[152:155], v[80:83], v[48:63]
    buffer_load_dwordx4 v143, s[12:15], s54 offen offset:2048 sc1 lds
    v_exp_f32 v115, v115
    v_fma_f32 v109, v109, v105, v105
    v_fma_f32 v110, v110, v105, v105
    v_mfma_f32_32x32x16_bf16 v[64:79], a[156:159], v[80:83], v[64:79]
    v_fma_f32 v111, v111, v105, v105
    v_fma_f32 v112, v112, v105, v105
    v_rcp_f32 v108, v108
    ds_read_b128 v[80:83], v3 offset:53248
    s_waitcnt lgkmcnt(3)
    v_mfma_f32_32x32x16_bf16 v[48:63], a[160:163], v[84:87], v[48:63]
    buffer_load_dwordx4 v143, s[12:15], s54 offen offset:3072 sc1 lds
    v_rcp_f32 v109, v109
    v_rcp_f32 v110, v110
    v_mfma_f32_32x32x16_bf16 v[64:79], a[164:167], v[84:87], v[64:79]
    v_rcp_f32 v111, v111
    v_fma_f32 v113, v113, v105, v105
    v_fma_f32 v114, v114, v105, v105
    ds_read_b128 v[84:87], v3 offset:54272
    s_waitcnt lgkmcnt(3)
    v_mfma_f32_32x32x16_bf16 v[48:63], a[168:171], v[88:91], v[48:63]
    buffer_load_dwordx4 v[196:199], v143, s[12:15], s53 offen offset:1024 sc1
    v_fma_f32 v115, v115, v105, v105
    v_mul_f32 v108, v108, v40
    v_rcp_f32 v112, v112
    v_mfma_f32_32x32x16_bf16 v[64:79], a[172:175], v[88:91], v[64:79]
    v_rcp_f32 v113, v113
    v_rcp_f32 v114, v114
    ds_read_b128 v[88:91], v3 offset:55296
    s_waitcnt lgkmcnt(3)
    v_mfma_f32_32x32x16_bf16 v[48:63], a[176:179], v[92:95], v[48:63]
    buffer_load_dwordx4 v[200:203], v143, s[12:15], s53 offen offset:2048 sc1
    v_rcp_f32 v115, v115
    v_mul_f32 v109, v109, v41
    v_mul_f32 v110, v110, v42
    v_mfma_f32_32x32x16_bf16 v[64:79], a[180:183], v[92:95], v[64:79]
    v_mul_f32 v111, v111, v43
    v_mul_f32 v112, v112, v44
    v_cvt_pk_bf16_f32 v120, v108, v109
    v_mul_f32 v113, v113, v45
    ds_read_b128 v[92:95], v3 offset:56320
    s_waitcnt lgkmcnt(3)
    v_mfma_f32_32x32x16_bf16 v[48:63], a[184:187], v[80:83], v[48:63]
    s_add_u32 m0, s73, 0
    s_nop 0
    buffer_load_dwordx4 v143, s[12:15], s55 offen offset:0 sc1 lds
    v_cvt_pk_bf16_f32 v121, v110, v111
    v_mul_f32 v114, v114, v46
    v_mul_f32 v115, v115, v47
    v_mfma_f32_32x32x16_bf16 v[64:79], a[188:191], v[80:83], v[64:79]
    v_cvt_pk_bf16_f32 v122, v112, v113
    v_cvt_pk_bf16_f32 v123, v114, v115
    buffer_store_dwordx4 v[120:123], v3, s[12:15], s40 offen offset:1024 sc1
    ds_read_b128 v[80:83], v3 offset:57344
    s_waitcnt lgkmcnt(3)
    v_mfma_f32_32x32x16_bf16 v[48:63], a[192:195], v[84:87], v[48:63]
    buffer_load_dwordx4 v143, s[12:15], s55 offen offset:1024 sc1 lds
    v_mfma_f32_32x32x16_bf16 v[64:79], a[196:199], v[84:87], v[64:79]
    ds_read_b128 v[84:87], v3 offset:58368
    s_waitcnt lgkmcnt(3)
    v_mfma_f32_32x32x16_bf16 v[48:63], a[200:203], v[88:91], v[48:63]
    buffer_load_dwordx4 v143, s[12:15], s55 offen offset:2048 sc1 lds
    v_mfma_f32_32x32x16_bf16 v[64:79], a[204:207], v[88:91], v[64:79]
    ds_read_b128 v[88:91], v7 offset:0
    s_waitcnt lgkmcnt(3)
    v_mfma_f32_32x32x16_bf16 v[48:63], a[208:211], v[92:95], v[48:63]
    buffer_load_dwordx4 v143, s[12:15], s55 offen offset:3072 sc1 lds
    v_mfma_f32_32x32x16_bf16 v[64:79], a[212:215], v[92:95], v[64:79]
    ds_read_b128 v[92:95], v7 offset:1024
    ds_read_b64 v[106:107], v8 offset:512
    s_waitcnt lgkmcnt(4)
    v_mfma_f32_32x32x16_bf16 v[48:63], a[216:219], v[80:83], v[48:63]
    v_mfma_f32_32x32x16_bf16 v[64:79], a[220:223], v[80:83], v[64:79]
    ds_read_b128 v[80:83], v7 offset:2048
    s_waitcnt lgkmcnt(4)
    v_mfma_f32_32x32x16_bf16 v[48:63], v[96:99], v[84:87], v[48:63]
    v_mfma_f32_32x32x16_bf16 v[64:79], v[100:103], v[84:87], v[64:79]
    ds_read_b128 v[84:87], v7 offset:3072
    s_waitcnt lgkmcnt(4)
    v_mfma_f32_32x32x16_bf16 v[16:31], a[0:3], v[88:91], 0
    buffer_load_dwordx4 v[204:207], v143, s[12:15], s53 offen offset:3072 sc1
    v_mfma_f32_32x32x16_bf16 v[32:47], a[4:7], v[88:91], 0
    ds_read_b128 v[88:91], v7 offset:4096
    s_waitcnt lgkmcnt(4)
    v_mfma_f32_32x32x16_bf16 v[16:31], a[8:11], v[92:95], v[16:31]
    buffer_load_dwordx4 v[224:227], v143, s[12:15], s57 offen offset:0 sc1
    v_mfma_f32_32x32x16_bf16 v[32:47], a[12:15], v[92:95], v[32:47]
    ds_read_b128 v[92:95], v7 offset:5120
    s_waitcnt lgkmcnt(3)
    v_mfma_f32_32x32x16_bf16 v[16:31], a[16:19], v[80:83], v[16:31]
    buffer_load_dwordx4 v[228:231], v143, s[12:15], s57 offen offset:1024 sc1
    v_mul_f32 v108, v48, v106
    v_mul_f32 v109, v49, v106
    v_mul_f32 v110, v50, v106
    v_mul_f32 v111, v51, v106
    v_mfma_f32_32x32x16_bf16 v[32:47], a[20:23], v[80:83], v[32:47]
    v_exp_f32 v108, v108
    v_exp_f32 v109, v109
    ds_read_b128 v[80:83], v7 offset:6144
    s_waitcnt lgkmcnt(3)
    v_mfma_f32_32x32x16_bf16 v[16:31], a[24:27], v[84:87], v[16:31]
    buffer_load_dwordx4 v[232:235], v143, s[12:15], s57 offen offset:2048 sc1
    v_exp_f32 v110, v110
    v_exp_f32 v111, v111
    v_mfma_f32_32x32x16_bf16 v[32:47], a[28:31], v[84:87], v[32:47]
    v_mul_f32 v112, v52, v106
    v_mul_f32 v113, v53, v106
    v_mul_f32 v114, v54, v106
    v_mul_f32 v115, v55, v106
    ds_read_b128 v[84:87], v7 offset:7168
    s_waitcnt lgkmcnt(3)
    v_mfma_f32_32x32x16_bf16 v[16:31], a[32:35], v[88:91], v[16:31]
    buffer_load_dwordx4 v[236:239], v143, s[12:15], s57 offen offset:3072 sc1
    v_exp_f32 v112, v112
    v_exp_f32 v113, v113
    v_mfma_f32_32x32x16_bf16 v[32:47], a[36:39], v[88:91], v[32:47]
    v_exp_f32 v114, v114
    v_exp_f32 v115, v115
    ds_read_b128 v[88:91], v7 offset:8192
    s_waitcnt lgkmcnt(3)
    v_mfma_f32_32x32x16_bf16 v[16:31], a[40:43], v[92:95], v[16:31]
    buffer_load_dwordx4 v[240:243], v143, s[12:15], s64 offen offset:0 sc1
    v_fma_f32 v108, v108, v107, v107
    v_fma_f32 v109, v109, v107, v107
    v_fma_f32 v110, v110, v107, v107
    v_fma_f32 v111, v111, v107, v107
    v_mfma_f32_32x32x16_bf16 v[32:47], a[44:47], v[92:95], v[32:47]
    s_branch PL_5
PE_5:
    .p2align 12
PT_5:
    s_branch PL_3
    s_nop 0
PL_5:
    v_fma_f32 v112, v112, v107, v107
    ds_read_b128 v[92:95], v7 offset:9216
    s_waitcnt lgkmcnt(3)
    v_mfma_f32_32x32x16_bf16 v[16:31], a[48:51], v[80:83], v[16:31]
    v_rcp_f32 v108, v108
    v_rcp_f32 v109, v109
    v_rcp_f32 v110, v110
    v_mfma_f32_32x32x16_bf16 v[32:47], a[52:55], v[80:83], v[32:47]
    v_rcp_f32 v111, v111
    v_fma_f32 v113, v113, v107, v107
    v_fma_f32 v114, v114, v107, v107
    ds_read_b128 v[80:83], v7 offset:10240
    s_waitcnt lgkmcnt(3)
    v_mfma_f32_32x32x16_bf16 v[16:31], a[56:59], v[84:87], v[16:31]
    buffer_load_dwordx4 v[244:247], v143, s[12:15], s64 offen offset:1024 sc1
    v_fma_f32 v115, v115, v107, v107
    v_mul_f32 v108, v108, v64
    v_rcp_f32 v112, v112
    v_mfma_f32_32x32x16_bf16 v[32:47], a[60:63], v[84:87], v[32:47]
    v_rcp_f32 v113, v113
    v_rcp_f32 v114, v114
    ds_read_b128 v[84:87], v7 offset:11264
    s_waitcnt lgkmcnt(3)
    v_mfma_f32_32x32x16_bf16 v[16:31], a[64:67], v[88:91], v[16:31]
    buffer_load_dwordx4 v[248:251], v143, s[12:15], s64 offen offset:2048 sc1
    v_rcp_f32 v115, v115
    v_mul_f32 v109, v109, v65
    v_mul_f32 v110, v110, v66
    v_mfma_f32_32x32x16_bf16 v[32:47], a[68:71], v[88:91], v[32:47]
    v_mul_f32 v111, v111, v67
    v_mul_f32 v112, v112, v68
    v_cvt_pk_bf16_f32 v116, v108, v109
    v_mul_f32 v113, v113, v69
    ds_read_b128 v[88:91], v7 offset:12288
    s_waitcnt lgkmcnt(3)
    v_mfma_f32_32x32x16_bf16 v[16:31], a[72:75], v[92:95], v[16:31]
    buffer_load_dwordx4 v[252:255], v143, s[12:15], s64 offen offset:3072 sc1
    v_cvt_pk_bf16_f32 v117, v110, v111
    v_mul_f32 v114, v114, v70
    v_mul_f32 v108, v56, v106
    v_mul_f32 v115, v115, v71
    v_mfma_f32_32x32x16_bf16 v[32:47], a[76:79], v[92:95], v[32:47]
    v_mul_f32 v109, v57, v106
    v_cvt_pk_bf16_f32 v118, v112, v113
    v_mul_f32 v110, v58, v106
    v_cvt_pk_bf16_f32 v119, v114, v115
    ds_read_b128 v[92:95], v7 offset:13312
    s_waitcnt lgkmcnt(3)
    v_mfma_f32_32x32x16_bf16 v[16:31], a[80:83], v[80:83], v[16:31]
    buffer_load_dwordx4 a[224:227], v143, s[12:15], s65 offen offset:0 sc1
    buffer_store_dwordx4 v[116:119], v3, s[12:15], s41 offen offset:0 sc1
    v_mul_f32 v111, v59, v106
    v_mul_f32 v112, v60, v106
    v_mfma_f32_32x32x16_bf16 v[32:47], a[84:87], v[80:83], v[32:47]
    v_exp_f32 v108, v108
    v_exp_f32 v109, v109
    ds_read_b128 v[80:83], v7 offset:14336
    s_waitcnt lgkmcnt(3)
    v_mfma_f32_32x32x16_bf16 v[16:31], a[88:91], v[84:87], v[16:31]
    buffer_load_dwordx4 a[228:231], v143, s[12:15], s65 offen offset:1024 sc1
    v_exp_f32 v110, v110
    v_exp_f32 v111, v111
    v_mfma_f32_32x32x16_bf16 v[32:47], a[92:95], v[84:87], v[32:47]
    v_mul_f32 v113, v61, v106
    v_mul_f32 v114, v62, v106
    v_mul_f32 v115, v63, v106
    v_fma_f32 v108, v108, v107, v107
    ds_read_b128 v[84:87], v7 offset:15360
    s_waitcnt vmcnt(15)
    s_barrier
    s_cmp_lg_u32 s3, 1
    s_waitcnt lgkmcnt(3)
    v_mfma_f32_32x32x16_bf16 v[16:31], a[96:99], v[88:91], v[16:31]
    s_cbranch_scc1 SIG_34
    s_atomic_add s74, s[30:31], 0
SIG_34:
    buffer_load_dwordx4 a[232:235], v143, s[12:15], s65 offen offset:2048 sc1
    v_fma_f32 v109, v109, v107, v107
    v_mfma_f32_32x32x16_bf16 v[32:47], a[100:103], v[88:91], v[32:47]
    v_exp_f32 v112, v112
    v_exp_f32 v113, v113
    ds_read_b128 v[88:91], v7 offset:16384
    s_waitcnt lgkmcnt(3)
    v_mfma_f32_32x32x16_bf16 v[16:31], a[104:107], v[92:95], v[16:31]
    v_exp_f32 v114, v114
    v_exp_f32 v115, v115
    v_fma_f32 v110, v110, v107, v107
    v_fma_f32 v111, v111, v107, v107
    v_mfma_f32_32x32x16_bf16 v[32:47], a[108:111], v[92:95], v[32:47]
    v_rcp_f32 v108, v108
    v_rcp_f32 v109, v109
    ds_read_b128 v[92:95], v7 offset:17408
    s_waitcnt lgkmcnt(3)
    v_mfma_f32_32x32x16_bf16 v[16:31], a[112:115], v[80:83], v[16:31]
    buffer_load_dwordx4 a[236:239], v143, s[12:15], s65 offen offset:3072 sc1
    v_rcp_f32 v110, v110
    v_rcp_f32 v111, v111
    v_mfma_f32_32x32x16_bf16 v[32:47], a[116:119], v[80:83], v[32:47]
    v_fma_f32 v112, v112, v107, v107
    v_fma_f32 v113, v113, v107, v107
    v_fma_f32 v114, v114, v107, v107
    v_fma_f32 v115, v115, v107, v107
    ds_read_b128 v[80:83], v7 offset:18432
    s_waitcnt lgkmcnt(3)
    v_mfma_f32_32x32x16_bf16 v[16:31], a[120:123], v[84:87], v[16:31]
    buffer_load_dwordx4 a[240:243], v143, s[12:15], s50 offen offset:0 sc1
    v_rcp_f32 v112, v112
    v_rcp_f32 v113, v113
    v_mfma_f32_32x32x16_bf16 v[32:47], a[124:127], v[84:87], v[32:47]
    v_rcp_f32 v114, v114
    v_rcp_f32 v115, v115
    ds_read_b128 v[84:87], v7 offset:19456
    s_waitcnt lgkmcnt(3)
    v_mfma_f32_32x32x16_bf16 v[16:31], a[128:131], v[88:91], v[16:31]
    buffer_load_dwordx4 a[244:247], v143, s[12:15], s50 offen offset:1024 sc1
    v_mul_f32 v108, v108, v72
    v_mul_f32 v109, v109, v73
    v_mul_f32 v110, v110, v74
    v_mul_f32 v111, v111, v75
    v_mfma_f32_32x32x16_bf16 v[32:47], a[132:135], v[88:91], v[32:47]
    v_mul_f32 v112, v112, v76
    v_cvt_pk_bf16_f32 v120, v108, v109
    v_mul_f32 v113, v113, v77
    v_cvt_pk_bf16_f32 v121, v110, v111
    ds_read_b128 v[88:91], v7 offset:20480
    s_waitcnt lgkmcnt(3)
    v_mfma_f32_32x32x16_bf16 v[16:31], a[136:139], v[92:95], v[16:31]
    buffer_load_dwordx4 a[248:251], v143, s[12:15], s50 offen offset:2048 sc1
    v_mul_f32 v114, v114, v78
    v_mul_f32 v115, v115, v79
    v_cvt_pk_bf16_f32 v122, v112, v113
    v_cvt_pk_bf16_f32 v123, v114, v115
    v_mfma_f32_32x32x16_bf16 v[32:47], a[140:143], v[92:95], v[32:47]
    buffer_store_dwordx4 v[120:123], v3, s[12:15], s41 offen offset:1024 sc1
    ds_read_b128 v[92:95], v7 offset:21504
    s_waitcnt lgkmcnt(3)
    v_mfma_f32_32x32x16_bf16 v[16:31], a[144:147], v[80:83], v[16:31]
    s_add_u32 m0, s73, 16384
    s_nop 0
    buffer_load_dwordx4 v143, s[12:15], s58 offen offset:0 sc1 lds
    v_mfma_f32_32x32x16_bf16 v[32:47], a[148:151], v[80:83], v[32:47]
    ds_read_b128 v[80:83], v7 offset:22528
    s_waitcnt lgkmcnt(3)
    v_mfma_f32_32x32x16_bf16 v[16:31], a[152:155], v[84:87], v[16:31]
    buffer_load_dwordx4 v143, s[12:15], s58 offen offset:1024 sc1 lds
    v_mfma_f32_32x32x16_bf16 v[32:47], a[156:159], v[84:87], v[32:47]
    ds_read_b128 v[84:87], v7 offset:23552
    s_cmp_lg_u32 s3, 0
    s_waitcnt lgkmcnt(3)
    v_mfma_f32_32x32x16_bf16 v[16:31], a[160:163], v[88:91], v[16:31]
    s_cbranch_scc1 MI_35
    s_mov_b32 s76, -1
    s_atomic_and s76, s[30:31], 0 glc
MI_35:
    v_mfma_f32_32x32x16_bf16 v[32:47], a[164:167], v[88:91], v[32:47]
    ds_read_b128 v[88:91], v7 offset:24576
    s_waitcnt lgkmcnt(3)
    v_mfma_f32_32x32x16_bf16 v[16:31], a[168:171], v[92:95], v[16:31]
    buffer_load_dwordx4 v143, s[12:15], s58 offen offset:2048 sc1 lds
    v_mfma_f32_32x32x16_bf16 v[32:47], a[172:175], v[92:95], v[32:47]
    ds_read_b128 v[92:95], v7 offset:25600
    s_waitcnt lgkmcnt(3)
    v_mfma_f32_32x32x16_bf16 v[16:31], a[176:179], v[80:83], v[16:31]
    buffer_load_dwordx4 v143, s[12:15], s58 offen offset:3072 sc1 lds
    v_mfma_f32_32x32x16_bf16 v[32:47], a[180:183], v[80:83], v[32:47]
    ds_read_b128 v[80:83], v7 offset:26624
    s_waitcnt lgkmcnt(3)
    v_mfma_f32_32x32x16_bf16 v[16:31], a[184:187], v[84:87], v[16:31]
    s_add_u32 m0, s73, 32768
    s_nop 0
    buffer_load_dwordx4 v143, s[12:15], s59 offen offset:0 sc1 lds
    v_mfma_f32_32x32x16_bf16 v[32:47], a[188:191], v[84:87], v[32:47]
    ds_read_b128 v[84:87], v7 offset:27648
    s_waitcnt lgkmcnt(3)
    v_mfma_f32_32x32x16_bf16 v[16:31], a[192:195], v[88:91], v[16:31]
    buffer_load_dwordx4 v143, s[12:15], s59 offen offset:1024 sc1 lds
    v_mfma_f32_32x32x16_bf16 v[32:47], a[196:199], v[88:91], v[32:47]
    ds_read_b128 v[88:91], v7 offset:28672
    s_waitcnt lgkmcnt(3)
    v_mfma_f32_32x32x16_bf16 v[16:31], a[200:203], v[92:95], v[16:31]
    buffer_load_dwordx4 v143, s[12:15], s59 offen offset:2048 sc1 lds
    v_mfma_f32_32x32x16_bf16 v[32:47], a[204:207], v[92:95], v[32:47]
    ds_read_b128 v[92:95], v7 offset:29696
    s_waitcnt lgkmcnt(3)
    v_mfma_f32_32x32x16_bf16 v[16:31], a[208:211], v[80:83], v[16:31]
    buffer_load_dwordx4 v143, s[12:15], s59 offen offset:3072 sc1 lds
    v_mfma_f32_32x32x16_bf16 v[32:47], a[212:215], v[80:83], v[32:47]
    ds_read_b128 v[80:83], v7 offset:30720
    ds_read_b64 v[104:105], v8 offset:1024
    s_waitcnt lgkmcnt(4)
    v_mfma_f32_32x32x16_bf16 v[16:31], a[216:219], v[84:87], v[16:31]
    v_mfma_f32_32x32x16_bf16 v[32:47], a[220:223], v[84:87], v[32:47]
    ds_read_b128 v[84:87], v7 offset:31744
    s_waitcnt lgkmcnt(4)
    v_mfma_f32_32x32x16_bf16 v[16:31], v[96:99], v[88:91], v[16:31]
    v_mfma_f32_32x32x16_bf16 v[32:47], v[100:103], v[88:91], v[32:47]
    ds_read_b128 v[88:91], v7 offset:32768
    s_waitcnt lgkmcnt(4)
    v_mfma_f32_32x32x16_bf16 v[48:63], a[0:3], v[92:95], 0
    buffer_load_dwordx4 a[252:255], v143, s[12:15], s50 offen offset:3072 sc1
    v_mfma_f32_32x32x16_bf16 v[64:79], a[4:7], v[92:95], 0
    ds_read_b128 v[92:95], v7 offset:33792
    s_waitcnt lgkmcnt(4)
    v_mfma_f32_32x32x16_bf16 v[48:63], a[8:11], v[80:83], v[48:63]
    buffer_load_dwordx4 v[208:211], v143, s[12:15], s56 offen offset:0 sc1
    v_mfma_f32_32x32x16_bf16 v[64:79], a[12:15], v[80:83], v[64:79]
    ds_read_b128 v[80:83], v7 offset:34816
    s_waitcnt lgkmcnt(3)
    v_mfma_f32_32x32x16_bf16 v[48:63], a[16:19], v[84:87], v[48:63]
    buffer_load_dwordx4 v[212:215], v143, s[12:15], s56 offen offset:1024 sc1
    v_mul_f32 v108, v16, v104
    v_mul_f32 v109, v17, v104
    v_mul_f32 v110, v18, v104
    v_mul_f32 v111, v19, v104
    v_mul_f32 v112, v20, v104
    v_mfma_f32_32x32x16_bf16 v[64:79], a[20:23], v[84:87], v[64:79]
    v_mul_f32 v113, v21, v104
    v_exp_f32 v108, v108
    v_exp_f32 v109, v109
    ds_read_b128 v[84:87], v7 offset:35840
    s_waitcnt lgkmcnt(3)
    v_mfma_f32_32x32x16_bf16 v[48:63], a[24:27], v[88:91], v[48:63]
    buffer_load_dwordx4 v[216:219], v143, s[12:15], s56 offen offset:2048 sc1
    v_mul_f32 v114, v22, v104
    v_exp_f32 v110, v110
    v_exp_f32 v111, v111
    v_mfma_f32_32x32x16_bf16 v[64:79], a[28:31], v[88:91], v[64:79]
    v_mul_f32 v115, v23, v104
    v_exp_f32 v112, v112
    v_exp_f32 v113, v113
    ds_read_b128 v[88:91], v7 offset:36864
    s_waitcnt lgkmcnt(3)
    v_mfma_f32_32x32x16_bf16 v[48:63], a[32:35], v[92:95], v[48:63]
    buffer_load_dwordx4 v[220:223], v143, s[12:15], s56 offen offset:3072 sc1
    v_fma_f32 v108, v108, v105, v105
    v_exp_f32 v114, v114
    v_exp_f32 v115, v115
    v_mfma_f32_32x32x16_bf16 v[64:79], a[36:39], v[92:95], v[64:79]
    v_fma_f32 v109, v109, v105, v105
    v_fma_f32 v110, v110, v105, v105
    v_fma_f32 v111, v111, v105, v105
    v_rcp_f32 v108, v108
    ds_read_b128 v[92:95], v7 offset:37888
    ds_read_b64 v[106:107], v8 offset:1536
    s_waitcnt lgkmcnt(4)
    v_mfma_f32_32x32x16_bf16 v[48:63], a[40:43], v[80:83], v[48:63]
    v_fma_f32 v112, v112, v105, v105
    v_rcp_f32 v109, v109
    v_rcp_f32 v110, v110
    v_rcp_f32 v111, v111
    v_mfma_f32_32x32x16_bf16 v[64:79], a[44:47], v[80:83], v[64:79]
    v_fma_f32 v113, v113, v105, v105
    v_fma_f32 v114, v114, v105, v105
    v_fma_f32 v115, v115, v105, v105
    v_rcp_f32 v112, v112
    ds_read_b128 v[80:83], v7 offset:38912
    s_cmp_lg_u32 s3, 0
    s_cbranch_scc1 MD_37
    s_mov_b32 s1, -1
MC_36:
    s_cmp_ge_i32 s76, 14
    s_cbranch_scc1 MD_37
    s_cmp_ge_i32 s77, 14
    s_cbranch_scc1 MD_37
    s_cmp_ge_i32 s78, 14
    s_cbranch_scc1 MD_37
    s_add_u32 s1, s1, 1
    s_cmp_gt_u32 s1, 4194304
    s_cbranch_scc1 MD_37
    s_and_b32 s0, s1, 3
    s_cbranch_scc1 MC_36
    s_cmp_lg_u32 s76, -1
    s_cbranch_scc1 MR_38
    s_cmp_lg_u32 s77, -1
    s_cbranch_scc1 MR_39
    s_cmp_lg_u32 s78, -1
    s_cbranch_scc1 MR_40
    s_branch MC_36
MR_38:
    s_cmp_ge_i32 s76, 14
    s_cbranch_scc1 MD_37
    s_mov_b32 s76, -1
    s_atomic_and s76, s[30:31], 0 glc
    s_branch MC_36
MR_39:
    s_cmp_ge_i32 s77, 14
    s_cbranch_scc1 MD_37
    s_mov_b32 s77, -1
    s_atomic_and s77, s[30:31], 0 glc
    s_branch MC_36
MR_40:
    s_cmp_ge_i32 s78, 14
    s_cbranch_scc1 MD_37
    s_mov_b32 s78, -1
    s_atomic_and s78, s[30:31], 0 glc
    s_branch MC_36
MD_37:
    s_waitcnt vmcnt(13)
    s_barrier
    s_cmp_lg_u32 s3, 1
    s_waitcnt lgkmcnt(4)
    v_mfma_f32_32x32x16_bf16 v[48:63], a[48:51], v[84:87], v[48:63]
    s_cbranch_scc1 SIG_41
    s_atomic_add s74, s[30:31], 128
SIG_41:
    s_mov_b32 m0, s71
    s_nop 0
    buffer_load_dwordx4 v127, s[12:15], s67 offen sc1 lds
    v_mul_f32 v108, v108, v32
    v_mfma_f32_32x32x16_bf16 v[64:79], a[52:55], v[84:87], v[64:79]
    v_mul_f32 v109, v109, v33
    v_rcp_f32 v113, v113
    v_rcp_f32 v114, v114
    ds_read_b128 v[84:87], v7 offset:39936
    s_waitcnt lgkmcnt(4)
    v_mfma_f32_32x32x16_bf16 v[48:63], a[56:59], v[88:91], v[48:63]
    s_add_u32 m0, s71, 1024
    s_nop 0
    buffer_load_dwordx4 v127, s[12:15], s68 offen sc1 lds
    s_add_u32 m0, s71, 2048
    s_mov_b64 exec, 0xffff
    buffer_load_dwordx4 v127, s[12:15], s69 offen sc1 lds
    s_mov_b64 exec, -1
    v_mfma_f32_32x32x16_bf16 v[64:79], a[60:63], v[88:91], v[64:79]
    v_mul_f32 v110, v110, v34
    v_rcp_f32 v115, v115
    v_mul_f32 v111, v111, v35
    v_mul_f32 v112, v112, v36
    ds_read_b128 v[88:91], v7 offset:40960
    s_waitcnt lgkmcnt(4)
    v_mfma_f32_32x32x16_bf16 v[48:63], a[64:67], v[92:95], v[48:63]
    buffer_load_dwordx4 a[0:3], v9, s[12:15], s50 offen sc1
    v_cvt_pk_bf16_f32 v116, v108, v109
    v_mul_f32 v113, v113, v37
    v_cvt_pk_bf16_f32 v117, v110, v111
    v_mul_f32 v114, v114, v38
    v_mul_f32 v108, v24, v104
    v_mfma_f32_32x32x16_bf16 v[64:79], a[68:71], v[92:95], v[64:79]
    v_mul_f32 v115, v115, v39
    v_mul_f32 v109, v25, v104
    v_cvt_pk_bf16_f32 v118, v112, v113
    v_mul_f32 v110, v26, v104
    v_cvt_pk_bf16_f32 v119, v114, v115
    ds_read_b128 v[92:95], v7 offset:41984
    s_waitcnt lgkmcnt(3)
    v_mfma_f32_32x32x16_bf16 v[48:63], a[72:75], v[80:83], v[48:63]
    buffer_load_dwordx4 a[4:7], v9, s[16:19], s50 offen sc1
    buffer_store_dwordx4 v[116:119], v3, s[12:15], s42 offen offset:0 sc1
    v_mul_f32 v111, v27, v104
    v_exp_f32 v108, v108
    v_mfma_f32_32x32x16_bf16 v[64:79], a[76:79], v[80:83], v[64:79]
    v_mul_f32 v112, v28, v104
    v_exp_f32 v109, v109
    v_exp_f32 v110, v110
    ds_read_b128 v[80:83], v7 offset:43008
    s_cmp_lg_u32 s3, 3
    s_waitcnt lgkmcnt(3)
    v_mfma_f32_32x32x16_bf16 v[48:63], a[80:83], v[84:87], v[48:63]
    s_cbranch_scc1 MI_42
    s_mov_b32 s76, -1
    s_atomic_and s76, s[30:31], 128 glc
MI_42:
    buffer_load_dwordx4 a[8:11], v9, s[12:15], s51 offen sc1
    v_mul_f32 v113, v29, v104
    v_mfma_f32_32x32x16_bf16 v[64:79], a[84:87], v[84:87], v[64:79]
    v_mul_f32 v114, v30, v104
    v_exp_f32 v111, v111
    v_mul_f32 v115, v31, v104
    v_fma_f32 v108, v108, v105, v105
    ds_read_b128 v[84:87], v7 offset:44032
    s_waitcnt lgkmcnt(3)
    v_mfma_f32_32x32x16_bf16 v[48:63], a[88:91], v[88:91], v[48:63]
    buffer_load_dwordx4 a[12:15], v9, s[16:19], s51 offen sc1
    v_fma_f32 v109, v109, v105, v105
    v_exp_f32 v112, v112
    v_exp_f32 v113, v113
    v_mfma_f32_32x32x16_bf16 v[64:79], a[92:95], v[88:91], v[64:79]
    v_fma_f32 v110, v110, v105, v105
    v_exp_f32 v114, v114
    v_exp_f32 v115, v115
    ds_read_b128 v[88:91], v7 offset:45056
    s_waitcnt lgkmcnt(3)
    v_mfma_f32_32x32x16_bf16 v[48:63], a[96:99], v[92:95], v[48:63]
    buffer_load_dwordx4 a[16:19], v9, s[12:15], s54 offen sc1
    v_fma_f32 v111, v111, v105, v105
    v_rcp_f32 v108, v108
    v_rcp_f32 v109, v109
    v_mfma_f32_32x32x16_bf16 v[64:79], a[100:103], v[92:95], v[64:79]
    v_fma_f32 v112, v112, v105, v105
    v_rcp_f32 v110, v110
    v_rcp_f32 v111, v111
    ds_read_b128 v[92:95], v7 offset:46080
    s_waitcnt lgkmcnt(3)
    v_mfma_f32_32x32x16_bf16 v[48:63], a[104:107], v[80:83], v[48:63]
    buffer_load_dwordx4 a[20:23], v9, s[16:19], s54 offen sc1
    v_fma_f32 v113, v113, v105, v105
    v_fma_f32 v114, v114, v105, v105
    v_fma_f32 v115, v115, v105, v105
    v_rcp_f32 v112, v112
    v_mfma_f32_32x32x16_bf16 v[64:79], a[108:111], v[80:83], v[64:79]
    v_mul_f32 v108, v108, v40
    v_rcp_f32 v113, v113
    v_rcp_f32 v114, v114
    ds_read_b128 v[80:83], v7 offset:47104
    s_cmp_lg_u32 s3, 3
    s_waitcnt lgkmcnt(3)
    v_mfma_f32_32x32x16_bf16 v[48:63], a[112:115], v[84:87], v[48:63]
    s_cbranch_scc1 MI_43
    s_mov_b32 s77, -1
    s_atomic_and s77, s[30:31], 128 glc
MI_43:
    buffer_load_dwordx4 a[24:27], v9, s[12:15], s55 offen sc1
    v_mul_f32 v109, v109, v41
    v_mfma_f32_32x32x16_bf16 v[64:79], a[116:119], v[84:87], v[64:79]
    v_mul_f32 v110, v110, v42
    v_rcp_f32 v115, v115
    v_mul_f32 v111, v111, v43
    v_mul_f32 v112, v112, v44
    ds_read_b128 v[84:87], v7 offset:48128
    s_waitcnt lgkmcnt(3)
    v_mfma_f32_32x32x16_bf16 v[48:63], a[120:123], v[88:91], v[48:63]
    buffer_load_dwordx4 a[28:31], v9, s[16:19], s55 offen sc1
    v_cvt_pk_bf16_f32 v120, v108, v109
    v_mul_f32 v113, v113, v45
    v_cvt_pk_bf16_f32 v121, v110, v111
    v_mul_f32 v114, v114, v46
    v_mul_f32 v115, v115, v47
    v_mfma_f32_32x32x16_bf16 v[64:79], a[124:127], v[88:91], v[64:79]
    v_cvt_pk_bf16_f32 v122, v112, v113
    v_cvt_pk_bf16_f32 v123, v114, v115
    buffer_store_dwordx4 v[120:123], v3, s[12:15], s42 offen offset:1024 sc1
    ds_read_b128 v[88:91], v7 offset:49152
    s_waitcnt lgkmcnt(3)
    v_mfma_f32_32x32x16_bf16 v[48:63], a[128:131], v[92:95], v[48:63]
    buffer_load_dwordx4 a[32:35], v9, s[12:15], s58 offen sc1
    v_mfma_f32_32x32x16_bf16 v[64:79], a[132:135], v[92:95], v[64:79]
    ds_read_b128 v[92:95], v7 offset:50176
    s_waitcnt lgkmcnt(3)
    v_mfma_f32_32x32x16_bf16 v[48:63], a[136:139], v[80:83], v[48:63]
    buffer_load_dwordx4 a[36:39], v9, s[16:19], s58 offen sc1
    v_mfma_f32_32x32x16_bf16 v[64:79], a[140:143], v[80:83], v[64:79]
    ds_read_b128 v[16:19], v7 offset:51200
    ds_read_b128 v[20:23], v7 offset:52224
    s_waitcnt lgkmcnt(4)
    v_mfma_f32_32x32x16_bf16 v[48:63], a[144:147], v[84:87], v[48:63]
    buffer_load_dwordx4 a[40:43], v9, s[12:15], s59 offen sc1
    v_mfma_f32_32x32x16_bf16 v[64:79], a[148:151], v[84:87], v[64:79]
    ds_read_b128 v[24:27], v7 offset:53248
    ds_read_b128 v[28:31], v7 offset:54272
    s_waitcnt lgkmcnt(5)
    v_mfma_f32_32x32x16_bf16 v[48:63], a[152:155], v[88:91], v[48:63]
    buffer_load_dwordx4 a[44:47], v9, s[16:19], s59 offen sc1
    v_mfma_f32_32x32x16_bf16 v[64:79], a[156:159], v[88:91], v[64:79]
    ds_read_b128 v[32:35], v7 offset:55296
    ds_read_b128 v[36:39], v7 offset:56320
    s_waitcnt lgkmcnt(6)
    v_mfma_f32_32x32x16_bf16 v[48:63], a[160:163], v[92:95], v[48:63]
    v_mfma_f32_32x32x16_bf16 v[64:79], a[164:167], v[92:95], v[64:79]
    ds_read_b128 v[40:43], v7 offset:57344
    s_waitcnt lgkmcnt(6)
    v_mfma_f32_32x32x16_bf16 v[48:63], a[168:171], v[16:19], v[48:63]
    v_mov_b64 v[128:129], 0
    ds_read_b128 v[44:47], v7 offset:58368
    s_waitcnt lgkmcnt(6)
    v_mfma_f32_32x32x16_bf16 v[48:63], a[176:179], v[20:23], v[48:63]
    v_mov_b64 v[130:131], 0
    s_cmp_lg_u32 s3, 3
    s_cbranch_scc1 MD_45
    s_mov_b32 s1, -1
MC_44:
    s_cmp_ge_i32 s76, 7
    s_cbranch_scc1 MD_45
    s_cmp_ge_i32 s77, 7
    s_cbranch_scc1 MD_45
    s_cmp_ge_i32 s78, 7
    s_cbranch_scc1 MD_45
    s_add_u32 s1, s1, 1
    s_cmp_gt_u32 s1, 4194304
    s_cbranch_scc1 MD_45
    s_and_b32 s0, s1, 3
    s_cbranch_scc1 MC_44
    s_cmp_lg_u32 s76, -1
    s_cbranch_scc1 MR_46
    s_cmp_lg_u32 s77, -1
    s_cbranch_scc1 MR_47
    s_cmp_lg_u32 s78, -1
    s_cbranch_scc1 MR_48
    s_branch MC_44
MR_46:
    s_cmp_ge_i32 s76, 7
    s_cbranch_scc1 MD_45
    s_mov_b32 s76, -1
    s_atomic_and s76, s[30:31], 128 glc
    s_branch MC_44
MR_47:
    s_cmp_ge_i32 s77, 7
    s_cbranch_scc1 MD_45
    s_mov_b32 s77, -1
    s_atomic_and s77, s[30:31], 128 glc
    s_branch MC_44
MR_48:
    s_cmp_ge_i32 s78, 7
    s_cbranch_scc1 MD_45
    s_mov_b32 s78, -1
    s_atomic_and s78, s[30:31], 128 glc
    s_branch MC_44
MD_45:
    s_barrier
    s_waitcnt lgkmcnt(5)
    v_mfma_f32_32x32x16_bf16 v[48:63], a[184:187], v[24:27], v[48:63]
    v_mov_b64 v[132:133], 0
    s_waitcnt lgkmcnt(4)
    v_mfma_f32_32x32x16_bf16 v[48:63], a[192:195], v[28:31], v[48:63]
    buffer_load_dwordx4 a[48:51], v142, s[12:15], s50 offen sc1
    v_mov_b64 v[134:135], 0
    s_waitcnt lgkmcnt(3)
    v_mfma_f32_32x32x16_bf16 v[48:63], a[200:203], v[32:35], v[48:63]
    v_mov_b64 v[136:137], 0
    s_waitcnt lgkmcnt(2)
    v_mfma_f32_32x32x16_bf16 v[48:63], a[208:211], v[36:39], v[48:63]
    buffer_load_dwordx4 a[52:55], v142, s[16:19], s50 offen sc1
    v_mov_b64 v[138:139], 0
    s_waitcnt lgkmcnt(1)
    v_mfma_f32_32x32x16_bf16 v[48:63], a[216:219], v[40:43], v[48:63]
    v_mov_b64 v[140:141], 0
    s_waitcnt lgkmcnt(0)
    v_mfma_f32_32x32x16_bf16 v[48:63], v[96:99], v[44:47], v[48:63]
    buffer_load_dwordx4 a[56:59], v142, s[12:15], s51 offen sc1
    v_mfma_f32_32x32x16_bf16 v[64:79], a[172:175], v[16:19], v[64:79]
    buffer_load_dwordx4 a[60:63], v142, s[16:19], s51 offen sc1
    ds_read_b128 v[80:83], v11 offset:0
    ds_read_b128 v[84:87], v11 offset:1024
    ds_read_b128 v[88:91], v11 offset:2048
    ds_read_b128 v[92:95], v11 offset:3072
    v_mfma_f32_32x32x16_bf16 v[64:79], a[180:183], v[20:23], v[64:79]
    buffer_load_dwordx4 a[64:67], v142, s[12:15], s54 offen sc1
    v_mfma_f32_32x32x16_bf16 v[64:79], a[188:191], v[24:27], v[64:79]
    s_nop 1
    v_mul_f32 v48, v48, v106
    v_mul_f32 v49, v49, v106
    v_mul_f32 v50, v50, v106
    v_mul_f32 v51, v51, v106
    v_exp_f32 v48, v48
    v_exp_f32 v49, v49
    v_mfma_f32_32x32x16_bf16 v[64:79], a[196:199], v[28:31], v[64:79]
    buffer_load_dwordx4 a[68:71], v142, s[16:19], s54 offen sc1
    v_exp_f32 v50, v50
    v_exp_f32 v51, v51
    v_fma_f32 v48, v48, v107, v107
    v_fma_f32 v49, v49, v107, v107
    v_mfma_f32_32x32x16_bf16 v[64:79], a[204:207], v[32:35], v[64:79]
    v_fma_f32 v50, v50, v107, v107
    v_fma_f32 v51, v51, v107, v107
    v_rcp_f32 v48, v48
    v_rcp_f32 v49, v49
    v_rcp_f32 v50, v50
    v_mfma_f32_32x32x16_bf16 v[64:79], a[212:215], v[36:39], v[64:79]
    buffer_load_dwordx4 a[72:75], v142, s[12:15], s55 offen sc1
    v_rcp_f32 v51, v51
    v_mul_f32 v52, v52, v106
    v_mul_f32 v53, v53, v106
    v_mul_f32 v54, v54, v106
    v_mul_f32 v55, v55, v106
    s_waitcnt vmcnt(11)
    s_barrier
    s_cmp_lg_u32 s3, 2
    v_mfma_f32_32x32x16_bf16 v[64:79], a[220:223], v[40:43], v[64:79]
    s_cbranch_scc1 SIG_49
    s_atomic_add s74, s[30:31], 256
SIG_49:
    v_exp_f32 v52, v52
    v_exp_f32 v53, v53
    v_exp_f32 v54, v54
    v_exp_f32 v55, v55
    v_mfma_f32_32x32x16_bf16 v[64:79], v[100:103], v[44:47], v[64:79]
    buffer_load_dwordx4 a[76:79], v142, s[16:19], s55 offen sc1
    v_fma_f32 v52, v52, v107, v107
    v_fma_f32 v53, v53, v107, v107
    v_fma_f32 v54, v54, v107, v107
    v_fma_f32 v55, v55, v107, v107
    v_rcp_f32 v52, v52
    s_cmp_lg_u32 s3, 1
    s_cbranch_scc1 MI_50
    s_mov_b32 s76, -1
    s_atomic_and s76, s[24:25], s79 offset:256 glc
MI_50:
    v_rcp_f32 v53, v53
    v_rcp_f32 v54, v54
    v_rcp_f32 v55, v55
    v_pk_mul_f32 v[56:57], v[56:57], v[106:107] op_sel_hi:[1,0]
    v_pk_mul_f32 v[58:59], v[58:59], v[106:107] op_sel_hi:[1,0]
    v_exp_f32 v56, v56
    v_exp_f32 v57, v57
    v_exp_f32 v58, v58
    v_exp_f32 v59, v59
    buffer_load_dwordx4 a[80:83], v142, s[12:15], s58 offen sc1
    v_pk_fma_f32 v[56:57], v[56:57], v[106:107], v[106:107] op_sel:[0,1,1] op_sel_hi:[1,1,1]
    v_pk_fma_f32 v[58:59], v[58:59], v[106:107], v[106:107] op_sel:[0,1,1] op_sel_hi:[1,1,1]
    v_rcp_f32 v56, v56
    v_rcp_f32 v57, v57
    v_rcp_f32 v58, v58
    v_rcp_f32 v59, v59
    v_pk_mul_f32 v[60:61], v[60:61], v[106:107] op_sel_hi:[1,0]
    v_pk_mul_f32 v[62:63], v[62:63], v[106:107] op_sel_hi:[1,0]
    v_exp_f32 v60, v60
    v_exp_f32 v61, v61
    buffer_load_dwordx4 a[84:87], v142, s[16:19], s58 offen sc1
    v_exp_f32 v62, v62
    v_exp_f32 v63, v63
    v_pk_fma_f32 v[60:61], v[60:61], v[106:107], v[106:107] op_sel:[0,1,1] op_sel_hi:[1,1,1]
    v_pk_fma_f32 v[62:63], v[62:63], v[106:107], v[106:107] op_sel:[0,1,1] op_sel_hi:[1,1,1]
    v_rcp_f32 v60, v60
    v_rcp_f32 v61, v61
    v_rcp_f32 v62, v62
    v_rcp_f32 v63, v63
    v_pk_mul_f32 v[48:49], v[48:49], v[64:65]
    v_pk_mul_f32 v[50:51], v[50:51], v[66:67]
    v_pk_mul_f32 v[52:53], v[52:53], v[68:69]
    v_pk_mul_f32 v[54:55], v[54:55], v[70:71]
    v_cvt_pk_bf16_f32 v116, v48, v49
    v_cvt_pk_bf16_f32 v117, v50, v51
    v_cvt_pk_bf16_f32 v118, v52, v53
    v_cvt_pk_bf16_f32 v119, v54, v55
    buffer_store_dwordx4 v[116:119], v3, s[12:15], s43 offen offset:0 sc1
    v_pk_mul_f32 v[56:57], v[56:57], v[72:73]
    v_pk_mul_f32 v[58:59], v[58:59], v[74:75]
    v_pk_mul_f32 v[60:61], v[60:61], v[76:77]
    v_pk_mul_f32 v[62:63], v[62:63], v[78:79]
    v_cvt_pk_bf16_f32 v120, v56, v57
    v_cvt_pk_bf16_f32 v121, v58, v59
    v_cvt_pk_bf16_f32 v122, v60, v61
    v_cvt_pk_bf16_f32 v123, v62, v63
    buffer_store_dwordx4 v[120:123], v3, s[12:15], s43 offen offset:1024 sc1
    s_branch PL_6
PE_6:
    .p2align 12
PT_6:
    s_branch PL_3
    s_nop 0
PL_6:
    v_mfma_f32_16x16x32_bf16 v[16:19], a[0:3], a[240:243], 0
    buffer_load_dwordx4 a[88:91], v142, s[12:15], s59 offen sc1
    v_mfma_f32_16x16x32_bf16 v[20:23], a[0:3], a[244:247], 0
    v_mfma_f32_16x16x32_bf16 v[24:27], a[0:3], a[248:251], 0
    v_mfma_f32_16x16x32_bf16 v[28:31], a[0:3], a[252:255], 0
    v_mfma_f32_16x16x32_bf16 v[32:35], a[4:7], a[240:243], 0
    buffer_load_dwordx4 a[92:95], v142, s[16:19], s59 offen sc1
    v_mfma_f32_16x16x32_bf16 v[36:39], a[4:7], a[244:247], 0
    v_mfma_f32_16x16x32_bf16 v[40:43], a[4:7], a[248:251], 0
    v_mfma_f32_16x16x32_bf16 v[44:47], a[4:7], a[252:255], 0
    s_waitcnt vmcnt(13)
    v_mfma_f32_16x16x32_bf16 v[48:51], a[48:51], a[240:243], 0
    s_cmp_lg_u32 s3, 1
    v_mfma_f32_16x16x32_bf16 v[52:55], a[48:51], a[244:247], 0
    s_cbranch_scc1 MI_51
    s_mov_b32 s77, -1
    s_atomic_and s77, s[24:25], s79 offset:256 glc
MI_51:
    v_mfma_f32_16x16x32_bf16 v[56:59], a[48:51], a[248:251], 0
    s_lshl_b32 s6, s35, 8
    s_add_u32 s6, s6, 2256896
    v_mfma_f32_16x16x32_bf16 v[60:63], a[48:51], a[252:255], 0
    s_waitcnt vmcnt(12)
    v_mfma_f32_16x16x32_bf16 v[64:67], a[52:55], a[240:243], 0
    ds_read_b128 v[96:99], v11 offset:16384
    v_mfma_f32_16x16x32_bf16 v[68:71], a[52:55], a[244:247], 0
    ds_read_b128 v[100:103], v11 offset:17408
    v_mfma_f32_16x16x32_bf16 v[72:75], a[52:55], a[248:251], 0
    v_mov_b64 v[122:123], 0
    v_lshlrev_b32 v4, 4, v4
    ds_read_b128 v[104:107], v11 offset:18432
    v_mfma_f32_16x16x32_bf16 v[76:79], a[52:55], a[252:255], 0
    ds_read_b128 v[108:111], v11 offset:19456
    s_waitcnt lgkmcnt(4)
    v_mfma_f32_16x16x32_bf16 v[16:19], a[8:11], v[80:83], v[16:19]
    v_mfma_f32_16x16x32_bf16 v[20:23], a[8:11], v[84:87], v[20:23]
    v_mfma_f32_16x16x32_bf16 v[24:27], a[8:11], v[88:91], v[24:27]
    buffer_load_dwordx4 v[112:115], v4, s[12:15], s6 offen sc1
    v_mfma_f32_16x16x32_bf16 v[28:31], a[8:11], v[92:95], v[28:31]
    v_mfma_f32_16x16x32_bf16 v[32:35], a[12:15], v[80:83], v[32:35]
    v_mfma_f32_16x16x32_bf16 v[36:39], a[12:15], v[84:87], v[36:39]
    v_mfma_f32_16x16x32_bf16 v[40:43], a[12:15], v[88:91], v[40:43]
    v_and_b32 v14, 4, v13
    v_sub_u32 v15, 2, v14
    v_mfma_f32_16x16x32_bf16 v[44:47], a[12:15], v[92:95], v[44:47]
    s_waitcnt vmcnt(12)
    v_mfma_f32_16x16x32_bf16 v[48:51], a[56:59], v[80:83], v[48:51]
    s_cmp_lg_u32 s3, 1
    v_mfma_f32_16x16x32_bf16 v[52:55], a[56:59], v[84:87], v[52:55]
    s_cbranch_scc1 MI_52
    s_mov_b32 s78, -1
    s_atomic_and s78, s[24:25], s79 offset:256 glc
MI_52:
    v_mfma_f32_16x16x32_bf16 v[56:59], a[56:59], v[88:91], v[56:59]
    v_add_u32 v14, v13, v15
    v_add_u32 v15, v14, v15
    v_mfma_f32_16x16x32_bf16 v[60:63], a[56:59], v[92:95], v[60:63]
    s_waitcnt vmcnt(11)
    v_mfma_f32_16x16x32_bf16 v[64:67], a[60:63], v[80:83], v[64:67]
    ds_read_b128 v[80:83], v10 offset:0
    v_mfma_f32_16x16x32_bf16 v[68:71], a[60:63], v[84:87], v[68:71]
    ds_read_b128 v[84:87], v10 offset:1024
    v_mfma_f32_16x16x32_bf16 v[72:75], a[60:63], v[88:91], v[72:75]
    ds_read_b128 v[88:91], v10 offset:2048
    v_mfma_f32_16x16x32_bf16 v[76:79], a[60:63], v[92:95], v[76:79]
    ds_read_b128 v[92:95], v10 offset:3072
    s_waitcnt lgkmcnt(4)
    v_mfma_f32_16x16x32_bf16 v[16:19], a[16:19], v[96:99], v[16:19]
    v_mfma_f32_16x16x32_bf16 v[20:23], a[16:19], v[100:103], v[20:23]
    v_mfma_f32_16x16x32_bf16 v[24:27], a[16:19], v[104:107], v[24:27]
    ds_read_u16_d16_hi v128, v12 offset:0
    v_mfma_f32_16x16x32_bf16 v[28:31], a[16:19], v[108:111], v[28:31]
    v_mfma_f32_16x16x32_bf16 v[32:35], a[20:23], v[96:99], v[32:35]
    v_mfma_f32_16x16x32_bf16 v[36:39], a[20:23], v[100:103], v[36:39]
    v_mfma_f32_16x16x32_bf16 v[40:43], a[20:23], v[104:107], v[40:43]
    v_mfma_f32_16x16x32_bf16 v[44:47], a[20:23], v[108:111], v[44:47]
    s_waitcnt vmcnt(10)
    v_mfma_f32_16x16x32_bf16 v[48:51], a[64:67], v[96:99], v[48:51]
    v_mfma_f32_16x16x32_bf16 v[52:55], a[64:67], v[100:103], v[52:55]
    v_mfma_f32_16x16x32_bf16 v[56:59], a[64:67], v[104:107], v[56:59]
    ds_read_u16_d16_hi v129, v12 offset:16
    v_mfma_f32_16x16x32_bf16 v[60:63], a[64:67], v[108:111], v[60:63]
    s_waitcnt vmcnt(9)
    v_mfma_f32_16x16x32_bf16 v[64:67], a[68:71], v[96:99], v[64:67]
    ds_read_b128 v[96:99], v10 offset:16384
    v_mfma_f32_16x16x32_bf16 v[68:71], a[68:71], v[100:103], v[68:71]
    ds_read_b128 v[100:103], v10 offset:17408
    v_mfma_f32_16x16x32_bf16 v[72:75], a[68:71], v[104:107], v[72:75]
    ds_read_b128 v[104:107], v10 offset:18432
    v_mfma_f32_16x16x32_bf16 v[76:79], a[68:71], v[108:111], v[76:79]
    ds_read_b128 v[108:111], v10 offset:19456
    s_waitcnt vmcnt(3)
    s_cmp_lg_u32 s3, 1
    s_cbranch_scc1 MD_54
    s_mov_b32 s1, -1
MC_53:
    s_cmp_ge_i32 s76, 7
    s_cbranch_scc1 MD_54
    s_cmp_ge_i32 s77, 7
    s_cbranch_scc1 MD_54
    s_cmp_ge_i32 s78, 7
    s_cbranch_scc1 MD_54
    s_add_u32 s1, s1, 1
    s_cmp_gt_u32 s1, 4194304
    s_cbranch_scc1 MD_54
    s_and_b32 s0, s1, 3
    s_cbranch_scc1 MC_53
    s_cmp_lg_u32 s76, -1
    s_cbranch_scc1 MR_55
    s_cmp_lg_u32 s77, -1
    s_cbranch_scc1 MR_56
    s_cmp_lg_u32 s78, -1
    s_cbranch_scc1 MR_57
    s_branch MC_53
MR_55:
    s_cmp_ge_i32 s76, 7
    s_cbranch_scc1 MD_54
    s_mov_b32 s76, -1
    s_atomic_and s76, s[24:25], s79 offset:256 glc
    s_branch MC_53
MR_56:
    s_cmp_ge_i32 s77, 7
    s_cbranch_scc1 MD_54
    s_mov_b32 s77, -1
    s_atomic_and s77, s[24:25], s79 offset:256 glc
    s_branch MC_53
MR_57:
    s_cmp_ge_i32 s78, 7
    s_cbranch_scc1 MD_54
    s_mov_b32 s78, -1
    s_atomic_and s78, s[24:25], s79 offset:256 glc
    s_branch MC_53
MD_54:
    s_barrier
    s_waitcnt lgkmcnt(6)
    v_mfma_f32_16x16x32_bf16 v[16:19], a[24:27], v[80:83], v[16:19]
    buffer_load_dwordx4 a[96:99], v142, s[12:15], s48 offen sc1
    s_cmp_lg_u32 s3, 0
    v_mfma_f32_16x16x32_bf16 v[20:23], a[24:27], v[84:87], v[20:23]
    s_cbranch_scc1 SIG_58
    s_atomic_add s74, s[30:31], 384
SIG_58:
    v_mfma_f32_16x16x32_bf16 v[24:27], a[24:27], v[88:91], v[24:27]
    ds_read_u16_d16_hi v130, v12 offset:32
    s_cmp_lg_u32 s3, 2
    v_mfma_f32_16x16x32_bf16 v[28:31], a[24:27], v[92:95], v[28:31]
    s_cbranch_scc1 MI_59
    s_mov_b32 s76, -1
    s_atomic_and s76, s[24:25], s79 offset:384 glc
MI_59:
    v_mfma_f32_16x16x32_bf16 v[32:35], a[28:31], v[80:83], v[32:35]
    buffer_load_dwordx4 a[100:103], v142, s[16:19], s48 offen sc1
    v_mfma_f32_16x16x32_bf16 v[36:39], a[28:31], v[84:87], v[36:39]
    v_mfma_f32_16x16x32_bf16 v[40:43], a[28:31], v[88:91], v[40:43]
    v_mfma_f32_16x16x32_bf16 v[44:47], a[28:31], v[92:95], v[44:47]
    v_mfma_f32_16x16x32_bf16 v[48:51], a[72:75], v[80:83], v[48:51]
    buffer_load_dwordx4 a[104:107], v142, s[12:15], s49 offen sc1
    v_mfma_f32_16x16x32_bf16 v[52:55], a[72:75], v[84:87], v[52:55]
    v_mfma_f32_16x16x32_bf16 v[56:59], a[72:75], v[88:91], v[56:59]
    ds_read_u16_d16_hi v131, v12 offset:48
    v_mfma_f32_16x16x32_bf16 v[60:63], a[72:75], v[92:95], v[60:63]
    v_mfma_f32_16x16x32_bf16 v[64:67], a[76:79], v[80:83], v[64:67]
    buffer_load_dwordx4 a[108:111], v142, s[16:19], s49 offen sc1
    ds_read_b128 v[80:83], v10 offset:32768
    v_mfma_f32_16x16x32_bf16 v[68:71], a[76:79], v[84:87], v[68:71]
    ds_read_b128 v[84:87], v10 offset:33792
    v_mfma_f32_16x16x32_bf16 v[72:75], a[76:79], v[88:91], v[72:75]
    ds_read_b128 v[88:91], v10 offset:34816
    v_mfma_f32_16x16x32_bf16 v[76:79], a[76:79], v[92:95], v[76:79]
    ds_read_b128 v[92:95], v10 offset:35840
    s_waitcnt lgkmcnt(6)
    v_mfma_f32_16x16x32_bf16 v[16:19], a[32:35], v[96:99], v[16:19]
    buffer_load_dwordx4 a[112:115], v142, s[12:15], s52 offen sc1
    s_cmp_lg_u32 s3, 2
    v_mfma_f32_16x16x32_bf16 v[20:23], a[32:35], v[100:103], v[20:23]
    s_cbranch_scc1 MI_60
    s_mov_b32 s77, -1
    s_atomic_and s77, s[24:25], s79 offset:384 glc
MI_60:
    v_mfma_f32_16x16x32_bf16 v[24:27], a[32:35], v[104:107], v[24:27]
    ds_read_u16_d16_hi v132, v13 offset:0
    v_mfma_f32_16x16x32_bf16 v[28:31], a[32:35], v[108:111], v[28:31]
    v_mfma_f32_16x16x32_bf16 v[32:35], a[36:39], v[96:99], v[32:35]
    buffer_load_dwordx4 a[116:119], v142, s[16:19], s52 offen sc1
    v_mfma_f32_16x16x32_bf16 v[36:39], a[36:39], v[100:103], v[36:39]
    v_mfma_f32_16x16x32_bf16 v[40:43], a[36:39], v[104:107], v[40:43]
    v_mfma_f32_16x16x32_bf16 v[44:47], a[36:39], v[108:111], v[44:47]
    v_mfma_f32_16x16x32_bf16 v[48:51], a[80:83], v[96:99], v[48:51]
    buffer_load_dwordx4 a[120:123], v142, s[12:15], s53 offen sc1
    v_mfma_f32_16x16x32_bf16 v[52:55], a[80:83], v[100:103], v[52:55]
    v_mfma_f32_16x16x32_bf16 v[56:59], a[80:83], v[104:107], v[56:59]
    ds_read_u16_d16_hi v133, v13 offset:16
    v_mfma_f32_16x16x32_bf16 v[60:63], a[80:83], v[108:111], v[60:63]
    v_mfma_f32_16x16x32_bf16 v[64:67], a[84:87], v[96:99], v[64:67]
    buffer_load_dwordx4 a[124:127], v142, s[16:19], s53 offen sc1
    ds_read_b32 v116, v6
    v_mfma_f32_16x16x32_bf16 v[68:71], a[84:87], v[100:103], v[68:71]
    ds_read_b32 v116, v6
    v_mfma_f32_16x16x32_bf16 v[72:75], a[84:87], v[104:107], v[72:75]
    ds_read_b32 v116, v6
    v_mfma_f32_16x16x32_bf16 v[76:79], a[84:87], v[108:111], v[76:79]
    ds_read_b32 v116, v6
    s_waitcnt lgkmcnt(6)
    v_mfma_f32_16x16x32_bf16 v[16:19], a[40:43], v[80:83], v[16:19]
    buffer_load_dwordx4 a[128:131], v142, s[12:15], s56 offen sc1
    s_cmp_lg_u32 s3, 2
    v_mfma_f32_16x16x32_bf16 v[20:23], a[40:43], v[84:87], v[20:23]
    s_cbranch_scc1 MI_61
    s_mov_b32 s78, -1
    s_atomic_and s78, s[24:25], s79 offset:384 glc
MI_61:
    v_mfma_f32_16x16x32_bf16 v[24:27], a[40:43], v[88:91], v[24:27]
    ds_read_u16_d16_hi v134, v13 offset:32
    v_mfma_f32_16x16x32_bf16 v[28:31], a[40:43], v[92:95], v[28:31]
    v_mfma_f32_16x16x32_bf16 v[32:35], a[44:47], v[80:83], v[32:35]
    buffer_load_dwordx4 a[132:135], v142, s[16:19], s56 offen sc1
    v_mfma_f32_16x16x32_bf16 v[36:39], a[44:47], v[84:87], v[36:39]
    v_mfma_f32_16x16x32_bf16 v[40:43], a[44:47], v[88:91], v[40:43]
    v_mfma_f32_16x16x32_bf16 v[44:47], a[44:47], v[92:95], v[44:47]
    s_waitcnt vmcnt(12)
    v_mfma_f32_16x16x32_bf16 v[48:51], a[88:91], v[80:83], v[48:51]
    buffer_load_dwordx4 a[136:139], v142, s[12:15], s57 offen sc1
    v_mfma_f32_16x16x32_bf16 v[52:55], a[88:91], v[84:87], v[52:55]
    v_mfma_f32_16x16x32_bf16 v[56:59], a[88:91], v[88:91], v[56:59]
    ds_read_u16_d16_hi v135, v13 offset:48
    v_mfma_f32_16x16x32_bf16 v[60:63], a[88:91], v[92:95], v[60:63]
    s_waitcnt vmcnt(12)
    v_mfma_f32_16x16x32_bf16 v[64:67], a[92:95], v[80:83], v[64:67]
    buffer_load_dwordx4 a[140:143], v142, s[16:19], s57 offen sc1
    v_mfma_f32_16x16x32_bf16 v[68:71], a[92:95], v[84:87], v[68:71]
    v_mfma_f32_16x16x32_bf16 v[72:75], a[92:95], v[88:91], v[72:75]
    v_mfma_f32_16x16x32_bf16 v[76:79], a[92:95], v[92:95], v[76:79]
    s_waitcnt vmcnt(11)
    v_mfma_f32_16x16x32_bf16 v[48:51], a[96:99], v[144:147], v[48:51]
    buffer_load_dwordx4 a[144:147], v142, s[12:15], s64 offen sc1
    v_mfma_f32_16x16x32_bf16 v[52:55], a[96:99], v[148:151], v[52:55]
    v_mfma_f32_16x16x32_bf16 v[56:59], a[96:99], v[152:155], v[56:59]
    ds_read_u16_d16_hi v136, v14 offset:0
    v_mfma_f32_16x16x32_bf16 v[60:63], a[96:99], v[156:159], v[60:63]
    s_waitcnt vmcnt(11)
    v_mfma_f32_16x16x32_bf16 v[64:67], a[100:103], v[144:147], v[64:67]
    buffer_load_dwordx4 a[148:151], v142, s[16:19], s64 offen sc1
    v_mfma_f32_16x16x32_bf16 v[68:71], a[100:103], v[148:151], v[68:71]
    v_mfma_f32_16x16x32_bf16 v[72:75], a[100:103], v[152:155], v[72:75]
    v_mfma_f32_16x16x32_bf16 v[76:79], a[100:103], v[156:159], v[76:79]
    s_waitcnt vmcnt(11)
    v_mfma_f32_16x16x32_bf16 v[48:51], a[104:107], v[160:163], v[48:51]
    buffer_load_dwordx4 a[152:155], v142, s[12:15], s65 offen sc1
    v_mfma_f32_16x16x32_bf16 v[52:55], a[104:107], v[164:167], v[52:55]
    v_mfma_f32_16x16x32_bf16 v[56:59], a[104:107], v[168:171], v[56:59]
    ds_read_u16_d16_hi v137, v14 offset:16
    v_mfma_f32_16x16x32_bf16 v[60:63], a[104:107], v[172:175], v[60:63]
    s_waitcnt vmcnt(11)
    v_mfma_f32_16x16x32_bf16 v[64:67], a[108:111], v[160:163], v[64:67]
    buffer_load_dwordx4 a[156:159], v142, s[16:19], s65 offen sc1
    v_mfma_f32_16x16x32_bf16 v[68:71], a[108:111], v[164:167], v[68:71]
    v_mfma_f32_16x16x32_bf16 v[72:75], a[108:111], v[168:171], v[72:75]
    s_cmp_lg_u32 s3, 2
    v_mfma_f32_16x16x32_bf16 v[76:79], a[108:111], v[172:175], v[76:79]
    s_cbranch_scc1 MD_63
    s_mov_b32 s1, -1
MC_62:
    s_cmp_ge_i32 s76, 7
    s_cbranch_scc1 MD_63
    s_cmp_ge_i32 s77, 7
    s_cbranch_scc1 MD_63
    s_cmp_ge_i32 s78, 7
    s_cbranch_scc1 MD_63
    s_add_u32 s1, s1, 1
    s_cmp_gt_u32 s1, 4194304
    s_cbranch_scc1 MD_63
    s_and_b32 s0, s1, 3
    s_cbranch_scc1 MC_62
    s_cmp_lg_u32 s76, -1
    s_cbranch_scc1 MR_64
    s_cmp_lg_u32 s77, -1
    s_cbranch_scc1 MR_65
    s_cmp_lg_u32 s78, -1
    s_cbranch_scc1 MR_66
    s_branch MC_62
MR_64:
    s_cmp_ge_i32 s76, 7
    s_cbranch_scc1 MD_63
    s_mov_b32 s76, -1
    s_atomic_and s76, s[24:25], s79 offset:384 glc
    s_branch MC_62
MR_65:
    s_cmp_ge_i32 s77, 7
    s_cbranch_scc1 MD_63
    s_mov_b32 s77, -1
    s_atomic_and s77, s[24:25], s79 offset:384 glc
    s_branch MC_62
MR_66:
    s_cmp_ge_i32 s78, 7
    s_cbranch_scc1 MD_63
    s_mov_b32 s78, -1
    s_atomic_and s78, s[24:25], s79 offset:384 glc
    s_branch MC_62
MD_63:
    s_barrier
    s_waitcnt vmcnt(11)
    v_mfma_f32_16x16x32_bf16 v[48:51], a[112:115], v[176:179], v[48:51]
    buffer_load_dwordx4 a[164:167], v9, s[16:19], s48 offen sc1
    v_mfma_f32_16x16x32_bf16 v[52:55], a[112:115], v[180:183], v[52:55]
    v_mfma_f32_16x16x32_bf16 v[56:59], a[112:115], v[184:187], v[56:59]
    ds_read_u16_d16_hi v138, v14 offset:32
    v_mfma_f32_16x16x32_bf16 v[60:63], a[112:115], v[188:191], v[60:63]
    s_waitcnt vmcnt(11)
    v_mfma_f32_16x16x32_bf16 v[64:67], a[116:119], v[176:179], v[64:67]
    buffer_load_dwordx4 a[172:175], v9, s[16:19], s49 offen sc1
    v_mfma_f32_16x16x32_bf16 v[68:71], a[116:119], v[180:183], v[68:71]
    v_mfma_f32_16x16x32_bf16 v[72:75], a[116:119], v[184:187], v[72:75]
    v_mfma_f32_16x16x32_bf16 v[76:79], a[116:119], v[188:191], v[76:79]
    s_waitcnt vmcnt(11)
    v_mfma_f32_16x16x32_bf16 v[48:51], a[120:123], v[192:195], v[48:51]
    buffer_load_dwordx4 a[180:183], v9, s[16:19], s52 offen sc1
    v_mfma_f32_16x16x32_bf16 v[52:55], a[120:123], v[196:199], v[52:55]
    v_mfma_f32_16x16x32_bf16 v[56:59], a[120:123], v[200:203], v[56:59]
    ds_read_u16_d16_hi v139, v14 offset:48
    v_mfma_f32_16x16x32_bf16 v[60:63], a[120:123], v[204:207], v[60:63]
    s_waitcnt vmcnt(11)
    v_mfma_f32_16x16x32_bf16 v[64:67], a[124:127], v[192:195], v[64:67]
    buffer_load_dwordx4 a[188:191], v9, s[16:19], s53 offen sc1
    v_mfma_f32_16x16x32_bf16 v[68:71], a[124:127], v[196:199], v[68:71]
    v_mfma_f32_16x16x32_bf16 v[72:75], a[124:127], v[200:203], v[72:75]
    v_mfma_f32_16x16x32_bf16 v[76:79], a[124:127], v[204:207], v[76:79]
    s_waitcnt vmcnt(11)
    v_mfma_f32_16x16x32_bf16 v[48:51], a[128:131], v[208:211], v[48:51]
    buffer_load_dwordx4 a[196:199], v9, s[16:19], s56 offen sc1
    v_mfma_f32_16x16x32_bf16 v[52:55], a[128:131], v[212:215], v[52:55]
    v_mfma_f32_16x16x32_bf16 v[56:59], a[128:131], v[216:219], v[56:59]
    ds_read_u16_d16_hi v140, v15 offset:0
    v_mfma_f32_16x16x32_bf16 v[60:63], a[128:131], v[220:223], v[60:63]
    s_waitcnt vmcnt(11)
    v_mfma_f32_16x16x32_bf16 v[64:67], a[132:135], v[208:211], v[64:67]
    buffer_load_dwordx4 a[204:207], v9, s[16:19], s57 offen sc1
    v_mfma_f32_16x16x32_bf16 v[68:71], a[132:135], v[212:215], v[68:71]
    v_mfma_f32_16x16x32_bf16 v[72:75], a[132:135], v[216:219], v[72:75]
    v_mfma_f32_16x16x32_bf16 v[76:79], a[132:135], v[220:223], v[76:79]
    s_waitcnt vmcnt(11)
    v_mfma_f32_16x16x32_bf16 v[48:51], a[136:139], v[224:227], v[48:51]
    buffer_load_dwordx4 a[212:215], v9, s[16:19], s64 offen sc1
    v_mfma_f32_16x16x32_bf16 v[52:55], a[136:139], v[228:231], v[52:55]
    v_mfma_f32_16x16x32_bf16 v[56:59], a[136:139], v[232:235], v[56:59]
    ds_read_u16_d16_hi v141, v15 offset:16
    v_mfma_f32_16x16x32_bf16 v[60:63], a[136:139], v[236:239], v[60:63]
    s_waitcnt vmcnt(11)
    v_mfma_f32_16x16x32_bf16 v[64:67], a[140:143], v[224:227], v[64:67]
    buffer_load_dwordx4 a[220:223], v9, s[16:19], s65 offen sc1
    v_mfma_f32_16x16x32_bf16 v[68:71], a[140:143], v[228:231], v[68:71]
    v_mfma_f32_16x16x32_bf16 v[72:75], a[140:143], v[232:235], v[72:75]
    v_mfma_f32_16x16x32_bf16 v[76:79], a[140:143], v[236:239], v[76:79]
    s_waitcnt vmcnt(11)
    v_mfma_f32_16x16x32_bf16 v[48:51], a[144:147], v[240:243], v[48:51]
    buffer_load_dwordx4 a[160:163], v9, s[12:15], s48 offen sc1
    v_mfma_f32_16x16x32_bf16 v[52:55], a[144:147], v[244:247], v[52:55]
    v_mfma_f32_16x16x32_bf16 v[56:59], a[144:147], v[248:251], v[56:59]
    ds_read_u16_d16_hi v122, v15 offset:32
    v_mfma_f32_16x16x32_bf16 v[60:63], a[144:147], v[252:255], v[60:63]
    s_waitcnt vmcnt(11)
    v_mfma_f32_16x16x32_bf16 v[64:67], a[148:151], v[240:243], v[64:67]
    buffer_load_dwordx4 a[168:171], v9, s[12:15], s49 offen sc1
    v_mfma_f32_16x16x32_bf16 v[68:71], a[148:151], v[244:247], v[68:71]
    v_mfma_f32_16x16x32_bf16 v[72:75], a[148:151], v[248:251], v[72:75]
    v_mfma_f32_16x16x32_bf16 v[76:79], a[148:151], v[252:255], v[76:79]
    s_waitcnt vmcnt(11)
    v_mfma_f32_16x16x32_bf16 v[48:51], a[152:155], a[224:227], v[48:51]
    buffer_load_dwordx4 a[176:179], v9, s[12:15], s52 offen sc1
    v_mfma_f32_16x16x32_bf16 v[52:55], a[152:155], a[228:231], v[52:55]
    v_mfma_f32_16x16x32_bf16 v[56:59], a[152:155], a[232:235], v[56:59]
    ds_read_u16_d16_hi v123, v15 offset:48
    v_mfma_f32_16x16x32_bf16 v[60:63], a[152:155], a[236:239], v[60:63]
    s_waitcnt vmcnt(11)
    v_mfma_f32_16x16x32_bf16 v[64:67], a[156:159], a[224:227], v[64:67]
    buffer_load_dwordx4 a[184:187], v9, s[12:15], s53 offen sc1
    v_mfma_f32_16x16x32_bf16 v[68:71], a[156:159], a[228:231], v[68:71]
    v_mfma_f32_16x16x32_bf16 v[72:75], a[156:159], a[232:235], v[72:75]
    v_mfma_f32_16x16x32_bf16 v[76:79], a[156:159], a[236:239], v[76:79]
    s_waitcnt vmcnt(11)
    v_mfma_f32_16x16x32_bf16 v[32:35], a[164:167], v[144:147], v[32:35]
    buffer_load_dwordx4 a[192:195], v9, s[12:15], s56 offen sc1
    v_mfma_f32_16x16x32_bf16 v[36:39], a[164:167], v[148:151], v[36:39]
    v_mfma_f32_16x16x32_bf16 v[40:43], a[164:167], v[152:155], v[40:43]
    ds_write_b128 v125, v[48:51] offset:0
    v_mfma_f32_16x16x32_bf16 v[44:47], a[164:167], v[156:159], v[44:47]
    s_waitcnt vmcnt(11)
    v_mfma_f32_16x16x32_bf16 v[32:35], a[172:175], v[160:163], v[32:35]
    buffer_load_dwordx4 a[200:203], v9, s[12:15], s57 offen sc1
    v_mfma_f32_16x16x32_bf16 v[36:39], a[172:175], v[164:167], v[36:39]
    v_mfma_f32_16x16x32_bf16 v[40:43], a[172:175], v[168:171], v[40:43]
    ds_write_b128 v125, v[52:55] offset:1024
    v_mfma_f32_16x16x32_bf16 v[44:47], a[172:175], v[172:175], v[44:47]
    s_waitcnt vmcnt(11)
    v_mfma_f32_16x16x32_bf16 v[32:35], a[180:183], v[176:179], v[32:35]
    buffer_load_dwordx4 a[208:211], v9, s[12:15], s64 offen sc1
    v_mfma_f32_16x16x32_bf16 v[36:39], a[180:183], v[180:183], v[36:39]
    v_mfma_f32_16x16x32_bf16 v[40:43], a[180:183], v[184:187], v[40:43]
    ds_write_b128 v125, v[56:59] offset:2048
    v_mfma_f32_16x16x32_bf16 v[44:47], a[180:183], v[188:191], v[44:47]
    s_waitcnt vmcnt(11)
    v_mfma_f32_16x16x32_bf16 v[32:35], a[188:191], v[192:195], v[32:35]
    buffer_load_dwordx4 a[216:219], v9, s[12:15], s65 offen sc1
    v_mfma_f32_16x16x32_bf16 v[36:39], a[188:191], v[196:199], v[36:39]
    v_mfma_f32_16x16x32_bf16 v[40:43], a[188:191], v[200:203], v[40:43]
    ds_write_b128 v125, v[60:63] offset:3072
    v_mfma_f32_16x16x32_bf16 v[44:47], a[188:191], v[204:207], v[44:47]
    s_waitcnt vmcnt(11)
    v_mfma_f32_16x16x32_bf16 v[32:35], a[196:199], v[208:211], v[32:35]
    v_mfma_f32_16x16x32_bf16 v[36:39], a[196:199], v[212:215], v[36:39]
    v_mfma_f32_16x16x32_bf16 v[40:43], a[196:199], v[216:219], v[40:43]
    ds_write_b128 v126, v[64:67] offset:0
    v_mfma_f32_16x16x32_bf16 v[44:47], a[196:199], v[220:223], v[44:47]
    s_waitcnt vmcnt(10)
    v_mfma_f32_16x16x32_bf16 v[32:35], a[204:207], v[224:227], v[32:35]
    v_mfma_f32_16x16x32_bf16 v[36:39], a[204:207], v[228:231], v[36:39]
    v_mfma_f32_16x16x32_bf16 v[40:43], a[204:207], v[232:235], v[40:43]
    ds_write_b128 v126, v[68:71] offset:1024
    v_mfma_f32_16x16x32_bf16 v[44:47], a[204:207], v[236:239], v[44:47]
    s_waitcnt vmcnt(9)
    v_mfma_f32_16x16x32_bf16 v[32:35], a[212:215], v[240:243], v[32:35]
    v_mfma_f32_16x16x32_bf16 v[36:39], a[212:215], v[244:247], v[36:39]
    v_mfma_f32_16x16x32_bf16 v[40:43], a[212:215], v[248:251], v[40:43]
    ds_write_b128 v126, v[72:75] offset:2048
    v_mfma_f32_16x16x32_bf16 v[44:47], a[212:215], v[252:255], v[44:47]
    s_waitcnt vmcnt(8)
    v_mfma_f32_16x16x32_bf16 v[32:35], a[220:223], a[224:227], v[32:35]
    v_mfma_f32_16x16x32_bf16 v[36:39], a[220:223], a[228:231], v[36:39]
    v_mfma_f32_16x16x32_bf16 v[40:43], a[220:223], a[232:235], v[40:43]
    ds_write_b128 v126, v[76:79] offset:3072
    v_mfma_f32_16x16x32_bf16 v[44:47], a[220:223], a[236:239], v[44:47]
    s_waitcnt vmcnt(7)
    v_mfma_f32_16x16x32_bf16 v[16:19], a[160:163], v[144:147], v[16:19]
    v_mfma_f32_16x16x32_bf16 v[20:23], a[160:163], v[148:151], v[20:23]
    v_mfma_f32_16x16x32_bf16 v[24:27], a[160:163], v[152:155], v[24:27]
    ds_write_b128 v124, v[32:35] offset:0
    v_mfma_f32_16x16x32_bf16 v[28:31], a[160:163], v[156:159], v[28:31]
    s_waitcnt vmcnt(6)
    v_mfma_f32_16x16x32_bf16 v[16:19], a[168:171], v[160:163], v[16:19]
    v_mfma_f32_16x16x32_bf16 v[20:23], a[168:171], v[164:167], v[20:23]
    v_mfma_f32_16x16x32_bf16 v[24:27], a[168:171], v[168:171], v[24:27]
    ds_write_b128 v124, v[36:39] offset:1024
    v_mfma_f32_16x16x32_bf16 v[28:31], a[168:171], v[172:175], v[28:31]
    s_waitcnt vmcnt(5)
    v_mfma_f32_16x16x32_bf16 v[16:19], a[176:179], v[176:179], v[16:19]
    v_mfma_f32_16x16x32_bf16 v[20:23], a[176:179], v[180:183], v[20:23]
    v_mfma_f32_16x16x32_bf16 v[24:27], a[176:179], v[184:187], v[24:27]
    ds_write_b128 v124, v[40:43] offset:2048
    v_mfma_f32_16x16x32_bf16 v[28:31], a[176:179], v[188:191], v[28:31]
    s_waitcnt vmcnt(4)
    v_mfma_f32_16x16x32_bf16 v[16:19], a[184:187], v[192:195], v[16:19]
    v_mfma_f32_16x16x32_bf16 v[20:23], a[184:187], v[196:199], v[20:23]
    v_mfma_f32_16x16x32_bf16 v[24:27], a[184:187], v[200:203], v[24:27]
    ds_write_b128 v124, v[44:47] offset:3072
    v_mfma_f32_16x16x32_bf16 v[28:31], a[184:187], v[204:207], v[28:31]
    s_waitcnt vmcnt(3)
    v_mfma_f32_16x16x32_bf16 v[16:19], a[192:195], v[208:211], v[16:19]
    v_mfma_f32_16x16x32_bf16 v[20:23], a[192:195], v[212:215], v[20:23]
    v_mfma_f32_16x16x32_bf16 v[24:27], a[192:195], v[216:219], v[24:27]
    v_mfma_f32_16x16x32_bf16 v[28:31], a[192:195], v[220:223], v[28:31]
    s_waitcnt lgkmcnt(0)
    s_barrier
    s_waitcnt vmcnt(2)
    v_mfma_f32_16x16x32_bf16 v[16:19], a[200:203], v[224:227], v[16:19]
    ds_read_b128 v[80:83], v1 offset:4096
    v_mfma_f32_16x16x32_bf16 v[20:23], a[200:203], v[228:231], v[20:23]
    ds_read_b128 v[84:87], v1 offset:5120
    v_mfma_f32_16x16x32_bf16 v[24:27], a[200:203], v[232:235], v[24:27]
    ds_read_b128 v[88:91], v1 offset:6144
    v_mfma_f32_16x16x32_bf16 v[28:31], a[200:203], v[236:239], v[28:31]
    ds_read_b128 v[92:95], v1 offset:7168
    s_waitcnt vmcnt(1)
    v_mfma_f32_16x16x32_bf16 v[16:19], a[208:211], v[240:243], v[16:19]
    ds_read_b128 v[96:99], v1 offset:8192
    v_mfma_f32_16x16x32_bf16 v[20:23], a[208:211], v[244:247], v[20:23]
    ds_read_b128 v[100:103], v1 offset:9216
    v_mfma_f32_16x16x32_bf16 v[24:27], a[208:211], v[248:251], v[24:27]
    ds_read_b128 v[104:107], v1 offset:10240
    v_mfma_f32_16x16x32_bf16 v[28:31], a[208:211], v[252:255], v[28:31]
    ds_read_b128 v[108:111], v1 offset:11264
    s_waitcnt vmcnt(0)
    v_mfma_f32_16x16x32_bf16 v[16:19], a[216:219], a[224:227], v[16:19]
    ds_read_b128 v[144:147], v1 offset:0
    v_mfma_f32_16x16x32_bf16 v[20:23], a[216:219], a[228:231], v[20:23]
    ds_read_b128 v[148:151], v1 offset:1024
    v_mfma_f32_16x16x32_bf16 v[24:27], a[216:219], a[232:235], v[24:27]
    ds_read_b128 v[152:155], v1 offset:2048
    v_mfma_f32_16x16x32_bf16 v[28:31], a[216:219], a[236:239], v[28:31]
    ds_read_b128 v[156:159], v1 offset:3072
    s_waitcnt lgkmcnt(4)
    v_pk_add_f32 v[80:81], v[80:81], v[96:97]
    v_pk_add_f32 v[82:83], v[82:83], v[98:99]
    v_pk_add_f32 v[84:85], v[84:85], v[100:101]
    v_pk_add_f32 v[86:87], v[86:87], v[102:103]
    v_pk_add_f32 v[88:89], v[88:89], v[104:105]
    v_pk_add_f32 v[90:91], v[90:91], v[106:107]
    v_pk_add_f32 v[92:93], v[92:93], v[108:109]
    v_pk_add_f32 v[94:95], v[94:95], v[110:111]
    s_waitcnt lgkmcnt(0)
    v_pk_add_f32 v[80:81], v[80:81], v[144:145]
    v_pk_add_f32 v[82:83], v[82:83], v[146:147]
    v_pk_add_f32 v[84:85], v[84:85], v[148:149]
    v_pk_add_f32 v[86:87], v[86:87], v[150:151]
    v_pk_add_f32 v[88:89], v[88:89], v[152:153]
    v_pk_add_f32 v[90:91], v[90:91], v[154:155]
    v_pk_add_f32 v[92:93], v[92:93], v[156:157]
    v_pk_add_f32 v[94:95], v[94:95], v[158:159]
    s_add_u32 s48, s72, 0
    s_add_u32 s49, s72, 57344
    s_add_u32 s50, s72, 114688
    s_add_u32 s51, s72, 172032
    v_pk_add_f32 v[80:81], v[80:81], v[16:17]
    v_pk_add_f32 v[84:85], v[84:85], v[20:21]
    v_pk_add_f32 v[88:89], v[88:89], v[24:25]
    v_pk_add_f32 v[92:93], v[92:93], v[28:29]
    v_pk_fma_f32 v[128:129], v[80:81], v[112:113], v[128:129] op_sel:[0,0,0] op_sel_hi:[1,0,1]
    v_pk_fma_f32 v[132:133], v[84:85], v[112:113], v[132:133] op_sel:[0,1,0] op_sel_hi:[1,1,1]
    v_pk_fma_f32 v[136:137], v[88:89], v[114:115], v[136:137] op_sel:[0,0,0] op_sel_hi:[1,0,1]
    v_pk_fma_f32 v[140:141], v[92:93], v[114:115], v[140:141] op_sel:[0,1,0] op_sel_hi:[1,1,1]
    v_cvt_pk_bf16_f32 v144, v128, v132
    v_cvt_pk_bf16_f32 v145, v136, v140
    buffer_store_dwordx2 v[144:145], v0, s[8:11], s48 offen sc1
    v_cvt_pk_bf16_f32 v146, v129, v133
    v_cvt_pk_bf16_f32 v147, v137, v141
    buffer_store_dwordx2 v[146:147], v0, s[8:11], s49 offen sc1
    v_pk_add_f32 v[82:83], v[82:83], v[18:19]
    v_pk_add_f32 v[86:87], v[86:87], v[22:23]
    v_pk_add_f32 v[90:91], v[90:91], v[26:27]
    v_pk_add_f32 v[94:95], v[94:95], v[30:31]
    v_pk_fma_f32 v[130:131], v[82:83], v[112:113], v[130:131] op_sel:[0,0,0] op_sel_hi:[1,0,1]
    v_pk_fma_f32 v[134:135], v[86:87], v[112:113], v[134:135] op_sel:[0,1,0] op_sel_hi:[1,1,1]
    v_pk_fma_f32 v[138:139], v[90:91], v[114:115], v[138:139] op_sel:[0,0,0] op_sel_hi:[1,0,1]
    v_pk_fma_f32 v[122:123], v[94:95], v[114:115], v[122:123] op_sel:[0,1,0] op_sel_hi:[1,1,1]
    v_cvt_pk_bf16_f32 v148, v130, v134
    v_cvt_pk_bf16_f32 v149, v138, v122
    buffer_store_dwordx2 v[148:149], v0, s[8:11], s50 offen sc1
    v_cvt_pk_bf16_f32 v150, v131, v135
    v_cvt_pk_bf16_f32 v151, v139, v123
    buffer_store_dwordx2 v[150:151], v0, s[8:11], s51 offen sc1
    s_endpgm
PE_7:
    .p2align 12
KP_SIDE:
    v_lshrrev_b32 v1, 6, v0
    v_and_b32 v2, 63, v0
    v_readfirstlane_b32 s3, v1
    v_lshrrev_b32 v6, 3, v2
    v_and_b32 v8, 7, v2
    s_mul_i32 s39, s3, 112
    v_add_u32 v7, s39, v6
    v_mul_u32_u24 v7, 5376, v7
    v_lshl_add_u32 v7, v8, 4, v7
    s_mul_i32 s62, s33, 24
    v_add_u32 v9, s62, v2
    v_add_u32 v11, 56, v9
    v_subrev_u32 v10, 112, v9
    v_min_u32 v9, v9, v10
    v_subrev_u32 v10, 112, v11
    v_min_u32 v11, v11, v10
    v_add_lshl_u32 v9, v9, s39, 1
    v_add_lshl_u32 v11, v11, s39, 1
    s_mul_i32 s62, s62, 5376
    s_mov_b32 s10, 2408448
    s_mov_b32 s11, 0x20000
    s_mov_b32 s46, 896
    s_mov_b32 s47, 0x20000
    s_mov_b32 s14, 15302656
    s_mov_b32 s15, 0x20000
    s_add_u32 s40, s32, 7
    s_lshl_b32 s40, s40, 7
    s_add_u32 s41, s33, 1
    s_mul_i32 s41, s41, 896
    s_add_u32 s41, s41, s40
    v_lshlrev_b32 v3, 4, v2
    v_and_b32 v4, 31, v2
    v_lshrrev_b32 v5, 5, v2
    s_and_b32 s42, s3, 1
    s_lshr_b32 s43, s3, 1
    s_mov_b32 s52, 0x3b124925
    s_mov_b32 s53, 0xc3e00000
    s_waitcnt lgkmcnt(0)
    s_mov_b32 s44, s22
    s_and_b32 s45, s23, 0xffff
    s_mov_b32 s8, s24
    s_and_b32 s9, s25, 0xffff
    s_mov_b32 s12, s30
    s_and_b32 s13, s31, 0xffff
    buffer_load_ushort v10, v9, s[44:47], 0 offen
    buffer_load_ushort v11, v11, s[44:47], 0 offen
    s_add_u32 s63, s62, s40
    buffer_load_dwordx4 v[16:19], v7, s[8:11], s63 offen
    s_add_u32 s62, s62, 43008
    s_add_u32 s63, s62, s40
    buffer_load_dwordx4 v[20:23], v7, s[8:11], s63 offen
    v_lshlrev_b32 v150, 3, v8
    v_add_u32 v150, v150, v6
    v_lshlrev_b32 v150, 2, v150
    s_lshl_b32 s57, s3, 8
    v_add_u32 v9, s57, v150
    v_lshlrev_b32 v241, 2, v2
    v_lshlrev_b32 v244, 2, v6
    v_mov_b32 v245, 0
    v_mov_b64 v[142:143], 0
    v_mov_b64 v[144:145], 0
    v_mov_b64 v[146:147], 0
    v_mov_b64 v[148:149], 0
    s_lshl_b32 s6, s33, 2
    v_lshl_add_u32 v12, v5, 1, s6
    s_add_u32 s62, s62, 43008
    s_add_u32 s63, s62, s40
    buffer_load_dwordx4 v[24:27], v7, s[8:11], s63 offen
    s_lshl_b32 s6, s32, 6
    v_add_u32 v150, s6, v12
    v_cvt_f32_u32 v150, v150
    v_lshlrev_b32 v12, 2, v12
    s_lshl_b32 s6, s43, 5
    v_add_u32 v151, s6, v4
    v_cmp_eq_u32 vcc, 0, v151
    v_cvt_f32_u32 v151, v151
    s_cmp_eq_u32 s42, 1
    s_cselect_b32 s6, 0xbe800000, 0
    s_cselect_b32 s7, 0x43600000, 0
    v_mov_b32 v152, s6
    v_mov_b32 v153, s7
    v_cndmask_b32 v153, v151, v153, vcc
    s_add_u32 s62, s62, 43008
    s_add_u32 s63, s62, s40
    buffer_load_dwordx4 v[28:31], v7, s[8:11], s63 offen
    v_cndmask_b32 v154, v152, 0, vcc
    v_mul_f32 v155, v153, v150
    v_mul_f32 v156, s52, v155
    v_floor_f32 v156, v156
    v_fma_f32 v155, v156, s53, v155
    v_fma_f32 v155, v155, s52, v154
    v_mul_f32 v156, s52, v153
    v_fmamk_f32 v176, v156, 0x00000000, v155
    v_fmamk_f32 v177, v156, 0x41800000, v155
    v_fmamk_f32 v178, v156, 0x42000000, v155
    v_fmamk_f32 v179, v156, 0x42400000, v155
    v_fmamk_f32 v180, v156, 0x3f800000, v155
    v_fmamk_f32 v181, v156, 0x41880000, v155
    v_fmamk_f32 v182, v156, 0x42040000, v155
    s_add_u32 s62, s62, 43008
    s_add_u32 s63, s62, s40
    buffer_load_dwordx4 v[32:35], v7, s[8:11], s63 offen
    v_fmamk_f32 v183, v156, 0x42440000, v155
    v_cos_f32 v176, v176
    v_cos_f32 v177, v177
    v_cos_f32 v178, v178
    v_cos_f32 v179, v179
    v_cos_f32 v180, v180
    v_cos_f32 v181, v181
    v_cos_f32 v182, v182
    s_add_u32 s62, s62, 43008
    s_cmp_eq_u32 s62, 602112
    s_cselect_b32 s62, 0, s62
    s_add_u32 s63, s62, s40
    buffer_load_dwordx4 v[36:39], v7, s[8:11], s63 offen
    v_cos_f32 v183, v183
    v_add_f32 v151, 0x42800000, v151
    v_mul_f32 v155, v151, v150
    v_mul_f32 v156, s52, v155
    v_floor_f32 v156, v156
    v_fma_f32 v155, v156, s53, v155
    v_fma_f32 v155, v155, s52, v152
    v_mul_f32 v156, s52, v151
    v_fmamk_f32 v184, v156, 0x00000000, v155
    v_fmamk_f32 v185, v156, 0x41800000, v155
    v_fmamk_f32 v186, v156, 0x42000000, v155
    v_fmamk_f32 v187, v156, 0x42400000, v155
    s_add_u32 s62, s62, 43008
    s_add_u32 s63, s62, s40
    buffer_load_dwordx4 v[40:43], v7, s[8:11], s63 offen
    v_fmamk_f32 v188, v156, 0x3f800000, v155
    v_fmamk_f32 v189, v156, 0x41880000, v155
    v_fmamk_f32 v190, v156, 0x42040000, v155
    v_fmamk_f32 v191, v156, 0x42440000, v155
    v_cos_f32 v184, v184
    v_cos_f32 v185, v185
    v_cos_f32 v186, v186
    v_cos_f32 v187, v187
    v_cos_f32 v188, v188
    s_add_u32 s62, s62, 43008
    s_add_u32 s63, s62, s40
    buffer_load_dwordx4 v[44:47], v7, s[8:11], s63 offen
    v_cos_f32 v189, v189
    v_cos_f32 v190, v190
    v_cos_f32 v191, v191
    v_add_f32 v151, 0x42800000, v151
    v_mul_f32 v155, v151, v150
    v_mul_f32 v156, s52, v155
    v_floor_f32 v156, v156
    v_fma_f32 v155, v156, s53, v155
    v_fma_f32 v155, v155, s52, v152
    v_mul_f32 v156, s52, v151
    v_fmamk_f32 v192, v156, 0x00000000, v155
    s_add_u32 s62, s62, 43008
    s_cmp_eq_u32 s62, 602112
    s_cselect_b32 s62, 0, s62
    s_add_u32 s63, s62, s40
    buffer_load_dwordx4 v[48:51], v7, s[8:11], s63 offen
    v_fmamk_f32 v193, v156, 0x41800000, v155
    v_fmamk_f32 v194, v156, 0x42000000, v155
    v_fmamk_f32 v195, v156, 0x42400000, v155
    v_fmamk_f32 v196, v156, 0x3f800000, v155
    v_fmamk_f32 v197, v156, 0x41880000, v155
    v_fmamk_f32 v198, v156, 0x42040000, v155
    v_fmamk_f32 v199, v156, 0x42440000, v155
    v_cos_f32 v192, v192
    v_cos_f32 v193, v193
    v_cos_f32 v194, v194
    v_cos_f32 v195, v195
    s_add_u32 s62, s62, 43008
    s_add_u32 s63, s62, s40
    buffer_load_dwordx4 v[52:55], v7, s[8:11], s63 offen
    v_cos_f32 v196, v196
    v_cos_f32 v197, v197
    v_cos_f32 v198, v198
    v_cos_f32 v199, v199
    v_add_f32 v151, 0x42800000, v151
    v_mul_f32 v155, v151, v150
    v_mul_f32 v156, s52, v155
    v_floor_f32 v156, v156
    v_fma_f32 v155, v156, s53, v155
    v_fma_f32 v155, v155, s52, v152
    v_mul_f32 v156, s52, v151
    v_fmamk_f32 v200, v156, 0x00000000, v155
    v_fmamk_f32 v201, v156, 0x41800000, v155
    v_fmamk_f32 v202, v156, 0x42000000, v155
    v_fmamk_f32 v203, v156, 0x42400000, v155
    v_fmamk_f32 v204, v156, 0x3f800000, v155
    v_fmamk_f32 v205, v156, 0x41880000, v155
    v_fmamk_f32 v206, v156, 0x42040000, v155
    v_fmamk_f32 v207, v156, 0x42440000, v155
    v_cos_f32 v200, v200
    s_waitcnt vmcnt(10)
    v_lshlrev_b32 v10, 16, v10
    v_lshlrev_b32 v11, 16, v11
    v_mul_f32 v246, 0xbfb8aa3b, v10
    v_mul_f32 v247, 0xbfb8aa3b, v11
    v_exp_f32 v246, v246
    v_exp_f32 v247, v247
    v_add_f32 v246, 1.0, v246
    v_add_f32 v247, 1.0, v247
    v_rcp_f32 v246, v246
    v_rcp_f32 v247, v247
    v_mul_f32 v10, v10, v246
    v_mul_f32 v11, v11, v247
    v_cvt_pk_bf16_f32 v10, v10, v245
    v_cvt_pk_bf16_f32 v11, v11, v245
    ds_bpermute_b32 v128, v244, v10 offset:0
    ds_bpermute_b32 v129, v244, v10 offset:32
    ds_bpermute_b32 v130, v244, v10 offset:64
    ds_bpermute_b32 v131, v244, v10 offset:96
    ds_bpermute_b32 v132, v244, v10 offset:128
    ds_bpermute_b32 v133, v244, v10 offset:160
    ds_bpermute_b32 v134, v244, v10 offset:192
    ds_bpermute_b32 v135, v244, v11 offset:0
    ds_bpermute_b32 v136, v244, v11 offset:32
    ds_bpermute_b32 v137, v244, v11 offset:64
    ds_bpermute_b32 v138, v244, v11 offset:96
    ds_bpermute_b32 v139, v244, v11 offset:128
    ds_bpermute_b32 v140, v244, v11 offset:160
    ds_bpermute_b32 v141, v244, v11 offset:192
    s_add_u32 s62, s62, 43008
    s_add_u32 s63, s62, s40
    buffer_load_dwordx4 v[56:59], v7, s[8:11], s63 offen
    s_add_u32 s62, s62, 43008
    s_cmp_eq_u32 s62, 602112
    s_cselect_b32 s62, 0, s62
    s_add_u32 s63, s62, s40
    buffer_load_dwordx4 v[60:63], v7, s[8:11], s63 offen
    v_cos_f32 v201, v201
    v_cos_f32 v202, v202
    v_cos_f32 v203, v203
    v_cos_f32 v204, v204
    v_cos_f32 v205, v205
    v_cos_f32 v206, v206
    v_cos_f32 v207, v207
    s_mul_i32 s58, s3, 28
    s_lshl_b32 s7, s32, 2
    s_add_u32 s58, s58, s7
    s_add_u32 s58, s58, s33
    s_lshl_b32 s58, s58, 10
    s_add_u32 s58, s58, 1835008
    s_mul_i32 s7, s33, 7
    s_add_u32 s7, s7, s32
    s_lshl_b32 s59, s7, 10
    s_add_u32 s59, s59, 2260992
    s_cmp_lt_u32 s7, 20
    s_cselect_b32 s59, s59, 0x7fff0000
    s_cmp_eq_u32 s3, 3
    s_cselect_b32 s59, s59, 0x7fff0000
    s_waitcnt vmcnt(11) lgkmcnt(13)
    s_add_u32 s62, s62, 43008
    s_add_u32 s63, s62, s40
    buffer_load_dwordx4 v[64:67], v7, s[8:11], s63 offen
    v_lshlrev_b32 v150, 16, v128
    v_dot2_f32_bf16 v142, v16, v128, v142
    v_dot2_f32_bf16 v144, v17, v128, v144
    v_dot2_f32_bf16 v146, v18, v128, v146
    v_dot2_f32_bf16 v148, v19, v128, v148
    v_dot2_f32_bf16 v143, v16, v150, v143
    v_dot2_f32_bf16 v145, v17, v150, v145
    v_dot2_f32_bf16 v147, v18, v150, v147
    v_dot2_f32_bf16 v149, v19, v150, v149
    s_waitcnt vmcnt(11) lgkmcnt(12)
    s_add_u32 s62, s62, 43008
    s_add_u32 s63, s62, s40
    buffer_load_dwordx4 v[68:71], v7, s[8:11], s63 offen
    v_lshlrev_b32 v150, 16, v129
    v_dot2_f32_bf16 v142, v20, v129, v142
    v_dot2_f32_bf16 v144, v21, v129, v144
    v_dot2_f32_bf16 v146, v22, v129, v146
    v_dot2_f32_bf16 v148, v23, v129, v148
    v_dot2_f32_bf16 v143, v20, v150, v143
    v_dot2_f32_bf16 v145, v21, v150, v145
    v_dot2_f32_bf16 v147, v22, v150, v147
    v_dot2_f32_bf16 v149, v23, v150, v149
    s_waitcnt vmcnt(11) lgkmcnt(11)
    v_lshlrev_b32 v150, 16, v130
    v_dot2_f32_bf16 v142, v24, v130, v142
    v_dot2_f32_bf16 v144, v25, v130, v144
    v_dot2_f32_bf16 v146, v26, v130, v146
    v_dot2_f32_bf16 v148, v27, v130, v148
    v_dot2_f32_bf16 v143, v24, v150, v143
    v_dot2_f32_bf16 v145, v25, v150, v145
    v_dot2_f32_bf16 v147, v26, v150, v147
    v_dot2_f32_bf16 v149, v27, v150, v149
    s_waitcnt vmcnt(10) lgkmcnt(10)
    v_lshlrev_b32 v150, 16, v131
    v_dot2_f32_bf16 v142, v28, v131, v142
    v_dot2_f32_bf16 v144, v29, v131, v144
    v_dot2_f32_bf16 v146, v30, v131, v146
    v_dot2_f32_bf16 v148, v31, v131, v148
    v_dot2_f32_bf16 v143, v28, v150, v143
    v_dot2_f32_bf16 v145, v29, v150, v145
    v_dot2_f32_bf16 v147, v30, v150, v147
    v_dot2_f32_bf16 v149, v31, v150, v149
    s_waitcnt vmcnt(9) lgkmcnt(9)
    v_lshlrev_b32 v150, 16, v132
    v_dot2_f32_bf16 v142, v32, v132, v142
    v_dot2_f32_bf16 v144, v33, v132, v144
    v_dot2_f32_bf16 v146, v34, v132, v146
    v_dot2_f32_bf16 v148, v35, v132, v148
    v_dot2_f32_bf16 v143, v32, v150, v143
    v_dot2_f32_bf16 v145, v33, v150, v145
    v_dot2_f32_bf16 v147, v34, v150, v147
    v_dot2_f32_bf16 v149, v35, v150, v149
    s_waitcnt vmcnt(8) lgkmcnt(8)
    v_lshlrev_b32 v150, 16, v133
    v_dot2_f32_bf16 v142, v36, v133, v142
    v_dot2_f32_bf16 v144, v37, v133, v144
    v_dot2_f32_bf16 v146, v38, v133, v146
    v_dot2_f32_bf16 v148, v39, v133, v148
    v_dot2_f32_bf16 v143, v36, v150, v143
    v_dot2_f32_bf16 v145, v37, v150, v145
    v_dot2_f32_bf16 v147, v38, v150, v147
    v_dot2_f32_bf16 v149, v39, v150, v149
    s_waitcnt vmcnt(7) lgkmcnt(7)
    v_lshlrev_b32 v150, 16, v134
    v_dot2_f32_bf16 v142, v40, v134, v142
    v_dot2_f32_bf16 v144, v41, v134, v144
    v_dot2_f32_bf16 v146, v42, v134, v146
    v_dot2_f32_bf16 v148, v43, v134, v148
    v_dot2_f32_bf16 v143, v40, v150, v143
    v_dot2_f32_bf16 v145, v41, v150, v145
    v_dot2_f32_bf16 v147, v42, v150, v147
    v_dot2_f32_bf16 v149, v43, v150, v149
    s_waitcnt vmcnt(6) lgkmcnt(6)
    v_lshlrev_b32 v150, 16, v135
    v_dot2_f32_bf16 v142, v44, v135, v142
    v_dot2_f32_bf16 v144, v45, v135, v144
    v_dot2_f32_bf16 v146, v46, v135, v146
    v_dot2_f32_bf16 v148, v47, v135, v148
    v_dot2_f32_bf16 v143, v44, v150, v143
    v_dot2_f32_bf16 v145, v45, v150, v145
    v_dot2_f32_bf16 v147, v46, v150, v147
    v_dot2_f32_bf16 v149, v47, v150, v149
    s_waitcnt vmcnt(5) lgkmcnt(5)
    v_lshlrev_b32 v150, 16, v136
    v_dot2_f32_bf16 v142, v48, v136, v142
    v_dot2_f32_bf16 v144, v49, v136, v144
    v_dot2_f32_bf16 v146, v50, v136, v146
    v_dot2_f32_bf16 v148, v51, v136, v148
    v_dot2_f32_bf16 v143, v48, v150, v143
    v_dot2_f32_bf16 v145, v49, v150, v145
    v_dot2_f32_bf16 v147, v50, v150, v147
    v_dot2_f32_bf16 v149, v51, v150, v149
    s_waitcnt vmcnt(4) lgkmcnt(4)
    v_lshlrev_b32 v150, 16, v137
    v_dot2_f32_bf16 v142, v52, v137, v142
    v_dot2_f32_bf16 v144, v53, v137, v144
    v_dot2_f32_bf16 v146, v54, v137, v146
    v_dot2_f32_bf16 v148, v55, v137, v148
    v_dot2_f32_bf16 v143, v52, v150, v143
    v_dot2_f32_bf16 v145, v53, v150, v145
    v_dot2_f32_bf16 v147, v54, v150, v147
    v_dot2_f32_bf16 v149, v55, v150, v149
    s_waitcnt vmcnt(3) lgkmcnt(3)
    v_lshlrev_b32 v150, 16, v138
    v_dot2_f32_bf16 v142, v56, v138, v142
    v_dot2_f32_bf16 v144, v57, v138, v144
    v_dot2_f32_bf16 v146, v58, v138, v146
    v_dot2_f32_bf16 v148, v59, v138, v148
    v_dot2_f32_bf16 v143, v56, v150, v143
    v_dot2_f32_bf16 v145, v57, v150, v145
    v_dot2_f32_bf16 v147, v58, v150, v147
    v_dot2_f32_bf16 v149, v59, v150, v149
    s_waitcnt vmcnt(2) lgkmcnt(2)
    v_lshlrev_b32 v150, 16, v139
    v_dot2_f32_bf16 v142, v60, v139, v142
    v_dot2_f32_bf16 v144, v61, v139, v144
    v_dot2_f32_bf16 v146, v62, v139, v146
    v_dot2_f32_bf16 v148, v63, v139, v148
    v_dot2_f32_bf16 v143, v60, v150, v143
    v_dot2_f32_bf16 v145, v61, v150, v145
    v_dot2_f32_bf16 v147, v62, v150, v147
    v_dot2_f32_bf16 v149, v63, v150, v149
    s_waitcnt vmcnt(1) lgkmcnt(1)
    v_lshlrev_b32 v150, 16, v140
    v_dot2_f32_bf16 v142, v64, v140, v142
    v_dot2_f32_bf16 v144, v65, v140, v144
    v_dot2_f32_bf16 v146, v66, v140, v146
    v_dot2_f32_bf16 v148, v67, v140, v148
    v_dot2_f32_bf16 v143, v64, v150, v143
    v_dot2_f32_bf16 v145, v65, v150, v145
    v_dot2_f32_bf16 v147, v66, v150, v147
    v_dot2_f32_bf16 v149, v67, v150, v149
    s_waitcnt vmcnt(0) lgkmcnt(0)
    v_lshlrev_b32 v150, 16, v141
    v_dot2_f32_bf16 v142, v68, v141, v142
    v_dot2_f32_bf16 v144, v69, v141, v144
    v_dot2_f32_bf16 v146, v70, v141, v146
    v_dot2_f32_bf16 v148, v71, v141, v148
    v_dot2_f32_bf16 v143, v68, v150, v143
    v_dot2_f32_bf16 v145, v69, v150, v145
    v_dot2_f32_bf16 v147, v70, v150, v147
    v_dot2_f32_bf16 v149, v71, v150, v149
    v_permlane32_swap_b32 v142, v146
    s_nop 0
    v_permlane32_swap_b32 v143, v147
    v_permlane32_swap_b32 v144, v148
    v_permlane32_swap_b32 v145, v149
    v_pk_add_f32 v[142:143], v[142:143], v[146:147]
    v_pk_add_f32 v[144:145], v[144:145], v[148:149]
    s_nop 1
    v_permlane16_swap_b32 v142, v144
    v_permlane16_swap_b32 v143, v145
    v_pk_add_f32 v[142:143], v[142:143], v[144:145]
    s_nop 1
    v_add_f32_dpp v144, v142, v142 row_ror:8 row_mask:0xf bank_mask:0xf
    s_nop 1
    v_add_f32_dpp v144, v143, v143 row_ror:8 row_mask:0xf bank_mask:0xc
    ds_write_b32 v9, v144 offset:0
    s_waitcnt lgkmcnt(0)
    s_barrier
    ds_read2st64_b32 v[142:143], v241 offset0:0 offset1:1
    ds_read2st64_b32 v[144:145], v241 offset0:2 offset1:3
    s_waitcnt lgkmcnt(0)
    v_pk_add_f32 v[142:143], v[142:143], v[144:145]
    v_add_f32 v142, v142, v143
    v_cvt_pk_bf16_f32 v142, v142, v142
    v_and_b32 v142, 0xffff0000, v142
    v_add_f32 v143, 1.0, v142
    v_cvt_pk_bf16_f32 v143, v143, v143
    v_and_b32 v143, 0xffff0000, v143
    ds_bpermute_b32 v160, v12, v143 offset:0
    ds_bpermute_b32 v161, v12, v143 offset:64
    ds_bpermute_b32 v162, v12, v143 offset:128
    ds_bpermute_b32 v163, v12, v143 offset:192
    ds_bpermute_b32 v164, v12, v143 offset:4
    ds_bpermute_b32 v165, v12, v143 offset:68
    ds_bpermute_b32 v166, v12, v143 offset:132
    ds_bpermute_b32 v167, v12, v143 offset:196
    s_waitcnt lgkmcnt(0)
    v_pk_mul_f32 v[176:177], v[176:177], v[160:161]
    v_pk_mul_f32 v[178:179], v[178:179], v[162:163]
    v_pk_mul_f32 v[180:181], v[180:181], v[164:165]
    v_pk_mul_f32 v[182:183], v[182:183], v[166:167]
    v_cvt_pk_bf16_f32 v16, v176, v177
    v_cvt_pk_bf16_f32 v17, v178, v179
    v_cvt_pk_bf16_f32 v18, v180, v181
    v_cvt_pk_bf16_f32 v19, v182, v183
    buffer_store_dwordx4 v[16:19], v3, s[12:15], s58 offen sc1
    s_add_u32 s58, s58, 114688
    v_pk_mul_f32 v[184:185], v[184:185], v[160:161]
    v_pk_mul_f32 v[186:187], v[186:187], v[162:163]
    v_pk_mul_f32 v[188:189], v[188:189], v[164:165]
    v_pk_mul_f32 v[190:191], v[190:191], v[166:167]
    v_cvt_pk_bf16_f32 v20, v184, v185
    v_cvt_pk_bf16_f32 v21, v186, v187
    v_cvt_pk_bf16_f32 v22, v188, v189
    v_cvt_pk_bf16_f32 v23, v190, v191
    buffer_store_dwordx4 v[20:23], v3, s[12:15], s58 offen sc1
    s_add_u32 s58, s58, 114688
    v_pk_mul_f32 v[192:193], v[192:193], v[160:161]
    v_pk_mul_f32 v[194:195], v[194:195], v[162:163]
    v_pk_mul_f32 v[196:197], v[196:197], v[164:165]
    v_pk_mul_f32 v[198:199], v[198:199], v[166:167]
    v_cvt_pk_bf16_f32 v24, v192, v193
    v_cvt_pk_bf16_f32 v25, v194, v195
    v_cvt_pk_bf16_f32 v26, v196, v197
    v_cvt_pk_bf16_f32 v27, v198, v199
    buffer_store_dwordx4 v[24:27], v3, s[12:15], s58 offen sc1
    s_add_u32 s58, s58, 114688
    s_cmp_eq_u32 s43, 1
    s_cselect_b32 s58, s59, s58
    s_cselect_b32 s6, 0, -1
    v_pk_mul_f32 v[200:201], v[200:201], v[160:161]
    v_pk_mul_f32 v[202:203], v[202:203], v[162:163]
    v_pk_mul_f32 v[204:205], v[204:205], v[164:165]
    v_pk_mul_f32 v[206:207], v[206:207], v[166:167]
    v_cvt_pk_bf16_f32 v28, v200, v201
    v_cvt_pk_bf16_f32 v29, v202, v203
    v_cvt_pk_bf16_f32 v30, v204, v205
    v_cvt_pk_bf16_f32 v31, v206, v207
    v_and_b32 v28, s6, v28
    v_and_b32 v29, s6, v29
    v_and_b32 v30, s6, v30
    v_and_b32 v31, s6, v31
    buffer_store_dwordx4 v[28:31], v3, s[12:15], s58 offen sc1
    s_load_dword s75, s[28:29], 0x0
    s_barrier
    s_add_u32 s62, s62, 43008
    s_cmp_eq_u32 s62, 602112
    s_cselect_b32 s62, 0, s62
    s_add_u32 s63, s62, s41
    buffer_load_dwordx4 v[72:75], v7, s[8:11], s63 offen
    s_add_u32 s62, s62, 43008
    s_add_u32 s63, s62, s41
    buffer_load_dwordx4 v[76:79], v7, s[8:11], s63 offen
    s_add_u32 s62, s62, 43008
    s_add_u32 s63, s62, s41
    buffer_load_dwordx4 v[80:83], v7, s[8:11], s63 offen
    s_add_u32 s62, s62, 43008
    s_add_u32 s63, s62, s41
    buffer_load_dwordx4 v[84:87], v7, s[8:11], s63 offen
    s_add_u32 s62, s62, 43008
    s_add_u32 s63, s62, s41
    buffer_load_dwordx4 v[88:91], v7, s[8:11], s63 offen
    s_add_u32 s62, s62, 43008
    s_cmp_eq_u32 s62, 602112
    s_cselect_b32 s62, 0, s62
    s_add_u32 s63, s62, s41
    buffer_load_dwordx4 v[92:95], v7, s[8:11], s63 offen
    s_add_u32 s62, s62, 43008
    s_add_u32 s63, s62, s41
    buffer_load_dwordx4 v[96:99], v7, s[8:11], s63 offen
    s_add_u32 s62, s62, 43008
    s_add_u32 s63, s62, s41
    buffer_load_dwordx4 v[100:103], v7, s[8:11], s63 offen
    s_lshr_b32 s36, s32, 1
    s_lshl_b32 s6, s33, 2
    s_add_u32 s36, s36, s6
    s_and_b32 s6, s32, 1
    s_mul_i32 s6, s6, 14
    s_add_u32 s37, s6, s36
    s_cmp_eq_u32 s42, 0
    s_cselect_b32 s48, s16, s18
    s_cselect_b32 s49, s17, s19
    s_and_b32 s49, s49, 0xffff
    s_cmp_lt_u32 s36, 14
    s_cselect_b32 s50, 1605632, 0
    s_mov_b32 s51, 0x20000
    v_bfe_u32 v150, v2, 4, 1
    v_lshlrev_b32 v150, 2, v150
    v_xor_b32 v150, v150, v8
    v_mul_u32_u24 v15, 3584, v6
    v_lshl_add_u32 v15, v150, 4, v15
    s_mul_i32 s54, s43, 802816
    s_lshl_b32 s6, s37, 7
    s_add_u32 s54, s54, s6
    s_mul_i32 s55, s42, 57344
    s_mul_i32 s6, s43, 28672
    s_add_u32 s56, s55, s6
    s_add_u32 m0, s56, 24576
    s_add_u32 s54, s54, 458752
    s_cmp_eq_u32 s43, 0
    s_cselect_b32 s64, 1, -1
    s_cselect_b32 s66, -27, s64
    s_cselect_b32 s68, s64, 27
    s_mul_i32 s65, s64, 28672
    s_mul_i32 s67, s66, 28672
    s_mul_i32 s69, s68, 28672
    s_lshl_b32 s64, s64, 10
    s_lshl_b32 s66, s66, 10
    s_lshl_b32 s68, s68, 10
    s_lshl_b32 s58, s32, 7
    s_lshl_b32 s6, s3, 12
    s_add_u32 s58, s58, s6
    s_add_u32 s24, s30, 2260992
    s_addc_u32 s25, s31, 0
    s_mov_b32 s74, 1
    s_lshl_b32 s6, s32, 6
    v_add_u32 v160, s6, v2
    v_cmp_le_u32 vcc, 224, v160
    v_sub_u32 v161, 448, v160
    s_nop 0
    v_cndmask_b32 v161, v160, v161, vcc
    v_cndmask_b32 v162, 0, 32, vcc
    v_cmp_eq_u32 vcc, 224, v161
    s_nop 1
    v_cndmask_b32 v161, v161, 0, vcc
    v_lshrrev_b32 v163, 5, v161
    v_lshl_add_u32 v162, v163, 6, v162
    v_and_b32 v161, 31, v161
    v_add_u32 v161, v161, v162
    s_mov_b32 s60, 2252800
    s_cmp_eq_u32 s33, 3
    s_cselect_b64 vcc, -1, 0
    s_cselect_b32 s60, 2256896, s60
    v_cndmask_b32 v161, v161, v160, vcc
    s_mov_b32 s61, 0x7fff0000
    s_cmp_eq_u32 s33, 1
    s_cselect_b32 s61, 2259968, s61
    s_cselect_b32 s60, 0x7fff0000, s60
    s_cmp_eq_u32 s33, 2
    s_cselect_b64 vcc, -1, 0
    s_cselect_b32 s60, 2254848, s60
    s_cselect_b32 s61, 2258944, s61
    v_lshlrev_b32 v161, 2, v161
    v_lshlrev_b32 v160, 1, v160
    v_mov_b64 v[142:143], 0
    v_mov_b64 v[144:145], 0
    v_mov_b64 v[146:147], 0
    v_mov_b64 v[148:149], 0
    s_waitcnt vmcnt(8) lgkmcnt(0)
    s_barrier
    s_cmp_lg_u32 s75, 0
    s_cbranch_scc1 BG_68
    s_mov_b32 s1, 0
    v_mov_b32 v242, 0
BS_67:
    s_sleep 8
    global_load_dword v243, v242, s[28:29] sc1
    s_add_u32 s1, s1, 1
    s_waitcnt vmcnt(0)
    v_readfirstlane_b32 s75, v243
    s_cmp_gt_u32 s1, 1048576
    s_cbranch_scc1 BG_68
    s_cmp_lg_u32 s75, 0
    s_cbranch_scc0 BS_67
BG_68:
    s_atomic_add s74, s[24:25], s58 offset:20480
    s_atomic_add s74, s[24:25], s58 offset:21504
    s_atomic_add s74, s[24:25], s58 offset:22528
    s_atomic_add s74, s[24:25], s58 offset:23552
    s_add_u32 s62, s62, 43008
    s_cmp_eq_u32 s62, 602112
    s_cselect_b32 s62, 0, s62
    s_add_u32 s63, s62, s41
    buffer_load_dwordx4 v[104:107], v7, s[8:11], s63 offen
    s_add_u32 s62, s62, 43008
    s_add_u32 s63, s62, s41
    buffer_load_dwordx4 v[108:111], v7, s[8:11], s63 offen
    s_add_u32 s62, s62, 43008
    s_add_u32 s63, s62, s41
    buffer_load_dwordx4 v[112:115], v7, s[8:11], s63 offen
    s_add_u32 s62, s62, 43008
    s_cmp_eq_u32 s62, 602112
    s_cselect_b32 s62, 0, s62
    s_add_u32 s63, s62, s41
    buffer_load_dwordx4 v[116:119], v7, s[8:11], s63 offen
    s_add_u32 s62, s62, 43008
    s_add_u32 s63, s62, s41
    buffer_load_dwordx4 v[120:123], v7, s[8:11], s63 offen
    s_add_u32 s62, s62, 43008
    s_add_u32 s63, s62, s41
    buffer_load_dwordx4 v[124:127], v7, s[8:11], s63 offen
    s_waitcnt vmcnt(13)
    v_lshlrev_b32 v150, 16, v128
    v_dot2_f32_bf16 v142, v72, v128, v142
    v_dot2_f32_bf16 v144, v73, v128, v144
    v_dot2_f32_bf16 v146, v74, v128, v146
    v_dot2_f32_bf16 v148, v75, v128, v148
    v_dot2_f32_bf16 v143, v72, v150, v143
    v_dot2_f32_bf16 v145, v73, v150, v145
    v_dot2_f32_bf16 v147, v74, v150, v147
    v_dot2_f32_bf16 v149, v75, v150, v149
    s_waitcnt vmcnt(12)
    v_lshlrev_b32 v150, 16, v129
    v_dot2_f32_bf16 v142, v76, v129, v142
    v_dot2_f32_bf16 v144, v77, v129, v144
    v_dot2_f32_bf16 v146, v78, v129, v146
    v_dot2_f32_bf16 v148, v79, v129, v148
    v_dot2_f32_bf16 v143, v76, v150, v143
    v_dot2_f32_bf16 v145, v77, v150, v145
    v_dot2_f32_bf16 v147, v78, v150, v147
    v_dot2_f32_bf16 v149, v79, v150, v149
    s_waitcnt vmcnt(11)
    v_lshlrev_b32 v150, 16, v130
    v_dot2_f32_bf16 v142, v80, v130, v142
    v_dot2_f32_bf16 v144, v81, v130, v144
    v_dot2_f32_bf16 v146, v82, v130, v146
    v_dot2_f32_bf16 v148, v83, v130, v148
    v_dot2_f32_bf16 v143, v80, v150, v143
    v_dot2_f32_bf16 v145, v81, v150, v145
    v_dot2_f32_bf16 v147, v82, v150, v147
    v_dot2_f32_bf16 v149, v83, v150, v149
    s_waitcnt vmcnt(10)
    v_lshlrev_b32 v150, 16, v131
    v_dot2_f32_bf16 v142, v84, v131, v142
    v_dot2_f32_bf16 v144, v85, v131, v144
    v_dot2_f32_bf16 v146, v86, v131, v146
    v_dot2_f32_bf16 v148, v87, v131, v148
    v_dot2_f32_bf16 v143, v84, v150, v143
    v_dot2_f32_bf16 v145, v85, v150, v145
    v_dot2_f32_bf16 v147, v86, v150, v147
    v_dot2_f32_bf16 v149, v87, v150, v149
    s_waitcnt vmcnt(9)
    v_lshlrev_b32 v150, 16, v132
    v_dot2_f32_bf16 v142, v88, v132, v142
    v_dot2_f32_bf16 v144, v89, v132, v144
    v_dot2_f32_bf16 v146, v90, v132, v146
    v_dot2_f32_bf16 v148, v91, v132, v148
    v_dot2_f32_bf16 v143, v88, v150, v143
    v_dot2_f32_bf16 v145, v89, v150, v145
    v_dot2_f32_bf16 v147, v90, v150, v147
    v_dot2_f32_bf16 v149, v91, v150, v149
    s_waitcnt vmcnt(8)
    v_lshlrev_b32 v150, 16, v133
    v_dot2_f32_bf16 v142, v92, v133, v142
    v_dot2_f32_bf16 v144, v93, v133, v144
    v_dot2_f32_bf16 v146, v94, v133, v146
    v_dot2_f32_bf16 v148, v95, v133, v148
    v_dot2_f32_bf16 v143, v92, v150, v143
    v_dot2_f32_bf16 v145, v93, v150, v145
    v_dot2_f32_bf16 v147, v94, v150, v147
    v_dot2_f32_bf16 v149, v95, v150, v149
    s_waitcnt vmcnt(7)
    v_lshlrev_b32 v150, 16, v134
    v_dot2_f32_bf16 v142, v96, v134, v142
    v_dot2_f32_bf16 v144, v97, v134, v144
    v_dot2_f32_bf16 v146, v98, v134, v146
    v_dot2_f32_bf16 v148, v99, v134, v148
    v_dot2_f32_bf16 v143, v96, v150, v143
    v_dot2_f32_bf16 v145, v97, v150, v145
    v_dot2_f32_bf16 v147, v98, v150, v147
    v_dot2_f32_bf16 v149, v99, v150, v149
    s_waitcnt vmcnt(6)
    v_lshlrev_b32 v150, 16, v135
    v_dot2_f32_bf16 v142, v100, v135, v142
    v_dot2_f32_bf16 v144, v101, v135, v144
    v_dot2_f32_bf16 v146, v102, v135, v146
    v_dot2_f32_bf16 v148, v103, v135, v148
    v_dot2_f32_bf16 v143, v100, v150, v143
    v_dot2_f32_bf16 v145, v101, v150, v145
    v_dot2_f32_bf16 v147, v102, v150, v147
    v_dot2_f32_bf16 v149, v103, v150, v149
    s_waitcnt vmcnt(5)
    v_lshlrev_b32 v150, 16, v136
    v_dot2_f32_bf16 v142, v104, v136, v142
    v_dot2_f32_bf16 v144, v105, v136, v144
    v_dot2_f32_bf16 v146, v106, v136, v146
    v_dot2_f32_bf16 v148, v107, v136, v148
    v_dot2_f32_bf16 v143, v104, v150, v143
    v_dot2_f32_bf16 v145, v105, v150, v145
    v_dot2_f32_bf16 v147, v106, v150, v147
    v_dot2_f32_bf16 v149, v107, v150, v149
    s_waitcnt vmcnt(4)
    v_lshlrev_b32 v150, 16, v137
    v_dot2_f32_bf16 v142, v108, v137, v142
    v_dot2_f32_bf16 v144, v109, v137, v144
    v_dot2_f32_bf16 v146, v110, v137, v146
    v_dot2_f32_bf16 v148, v111, v137, v148
    v_dot2_f32_bf16 v143, v108, v150, v143
    v_dot2_f32_bf16 v145, v109, v150, v145
    v_dot2_f32_bf16 v147, v110, v150, v147
    v_dot2_f32_bf16 v149, v111, v150, v149
    s_waitcnt vmcnt(3)
    v_lshlrev_b32 v150, 16, v138
    v_dot2_f32_bf16 v142, v112, v138, v142
    v_dot2_f32_bf16 v144, v113, v138, v144
    v_dot2_f32_bf16 v146, v114, v138, v146
    v_dot2_f32_bf16 v148, v115, v138, v148
    v_dot2_f32_bf16 v143, v112, v150, v143
    v_dot2_f32_bf16 v145, v113, v150, v145
    v_dot2_f32_bf16 v147, v114, v150, v147
    v_dot2_f32_bf16 v149, v115, v150, v149
    s_waitcnt vmcnt(2)
    v_lshlrev_b32 v150, 16, v139
    v_dot2_f32_bf16 v142, v116, v139, v142
    v_dot2_f32_bf16 v144, v117, v139, v144
    v_dot2_f32_bf16 v146, v118, v139, v146
    v_dot2_f32_bf16 v148, v119, v139, v148
    v_dot2_f32_bf16 v143, v116, v150, v143
    v_dot2_f32_bf16 v145, v117, v150, v145
    v_dot2_f32_bf16 v147, v118, v150, v147
    v_dot2_f32_bf16 v149, v119, v150, v149
    s_waitcnt vmcnt(1)
    v_lshlrev_b32 v150, 16, v140
    v_dot2_f32_bf16 v142, v120, v140, v142
    v_dot2_f32_bf16 v144, v121, v140, v144
    v_dot2_f32_bf16 v146, v122, v140, v146
    v_dot2_f32_bf16 v148, v123, v140, v148
    v_dot2_f32_bf16 v143, v120, v150, v143
    v_dot2_f32_bf16 v145, v121, v150, v145
    v_dot2_f32_bf16 v147, v122, v150, v147
    v_dot2_f32_bf16 v149, v123, v150, v149
    s_waitcnt vmcnt(0)
    v_lshlrev_b32 v150, 16, v141
    v_dot2_f32_bf16 v142, v124, v141, v142
    v_dot2_f32_bf16 v144, v125, v141, v144
    v_dot2_f32_bf16 v146, v126, v141, v146
    v_dot2_f32_bf16 v148, v127, v141, v148
    v_dot2_f32_bf16 v143, v124, v150, v143
    v_dot2_f32_bf16 v145, v125, v150, v145
    v_dot2_f32_bf16 v147, v126, v150, v147
    v_dot2_f32_bf16 v149, v127, v150, v149
    v_permlane32_swap_b32 v142, v146
    s_nop 0
    v_permlane32_swap_b32 v143, v147
    v_permlane32_swap_b32 v144, v148
    v_permlane32_swap_b32 v145, v149
    v_pk_add_f32 v[142:143], v[142:143], v[146:147]
    v_pk_add_f32 v[144:145], v[144:145], v[148:149]
    s_nop 1
    v_permlane16_swap_b32 v142, v144
    v_permlane16_swap_b32 v143, v145
    v_pk_add_f32 v[142:143], v[142:143], v[144:145]
    s_nop 1
    v_add_f32_dpp v144, v142, v142 row_ror:8 row_mask:0xf bank_mask:0xf
    s_nop 1
    v_add_f32_dpp v144, v143, v143 row_ror:8 row_mask:0xf bank_mask:0xc
    ds_write_b32 v9, v144 offset:1024
    s_waitcnt lgkmcnt(0)
    s_barrier
    s_cmp_lg_u32 s3, 0
    s_cbranch_scc1 SD_G4
    ds_read2st64_b32 v[142:143], v241 offset0:4 offset1:5
    ds_read2st64_b32 v[144:145], v241 offset0:6 offset1:7
    s_waitcnt lgkmcnt(0)
    v_pk_add_f32 v[142:143], v[142:143], v[144:145]
    v_add_f32 v142, v142, v143
    v_cvt_pk_bf16_f32 v142, v142, v142
    v_and_b32 v142, 0xffff0000, v142
    v_add_f32 v143, 1.0, v142
    v_cvt_pk_bf16_f32 v143, v143, v143
    v_and_b32 v143, 0xffff0000, v143
    v_cndmask_b32 v142, v142, v143, vcc
    buffer_store_dword v142, v161, s[12:15], s60 offen sc1
    buffer_store_short_d16_hi v142, v160, s[12:15], s61 offen sc1
    s_barrier
    s_waitcnt vmcnt(0)
    s_atomic_add s74, s[24:25], 21376
    s_atomic_add s74, s[24:25], 23424
    s_atomic_add s74, s[24:25], 25472
    s_atomic_add s74, s[24:25], 27520
    s_atomic_add s74, s[24:25], 29568
    s_atomic_add s74, s[24:25], 31616
    s_atomic_add s74, s[24:25], 33664
    s_atomic_add s74, s[24:25], 35712
    s_atomic_add s74, s[24:25], 24448
    s_atomic_add s74, s[24:25], 26496
    s_branch SD_G3
SD_G4:
    s_barrier
SD_G3:
    s_cmp_lt_u32 s36, 14
    s_cbranch_scc0 KP_END
    buffer_load_dwordx4 v15, s[48:51], s54 offen lds
    s_lshr_b32 s38, s37, 1
    s_lshl_b32 s38, s38, 7
    s_add_u32 s38, s38, 16384
    s_add_u32 m0, m0, s64
    s_add_u32 s54, s54, s65
    buffer_load_dwordx4 v15, s[48:51], s54 offen lds
    s_and_b32 s39, s32, 1
    s_lshl_b32 s39, s39, 11
    s_add_u32 s39, s39, 24448
    s_add_u32 m0, m0, s64
    s_add_u32 s54, s54, s65
    buffer_load_dwordx4 v15, s[48:51], s54 offen lds
    v_bfe_u32 v150, v2, 2, 2
    v_lshl_add_u32 v151, v5, 3, v150
    v_lshlrev_b32 v8, 7, v151
    s_add_u32 m0, m0, s64
    s_add_u32 s54, s54, s65
    buffer_load_dwordx4 v15, s[48:51], s54 offen lds
    v_lshrrev_b32 v150, 1, v150
    v_xor_b32 v150, s43, v150
    v_lshl_add_u32 v8, v150, 6, v8
    s_add_u32 m0, m0, s64
    s_add_u32 s54, s54, s65
    buffer_load_dwordx4 v15, s[48:51], s54 offen lds
    v_bfe_u32 v150, v2, 4, 1
    v_lshl_add_u32 v8, v150, 5, v8
    v_and_b32 v150, 3, v2
    s_add_u32 m0, m0, s64
    s_add_u32 s54, s54, s65
    buffer_load_dwordx4 v15, s[48:51], s54 offen lds
    v_lshl_add_u32 v8, v150, 3, v8
    s_add_u32 s55, s55, 8192
    v_add_u32 v8, s55, v8
    s_add_u32 m0, m0, s64
    s_add_u32 s54, s54, s65
    buffer_load_dwordx4 v15, s[48:51], s54 offen lds
    v_and_b32 v9, 1, v2
    v_mul_u32_u24 v9, 1152, v9
    v_lshl_add_u32 v9, v5, 4, v9
    s_add_u32 m0, m0, s64
    s_add_u32 s54, s54, s65
    buffer_load_dwordx4 v15, s[48:51], s54 offen lds
    s_lshl_b32 s19, s37, 2
    s_add_u32 s19, s19, s3
    s_lshl_b32 s19, s19, 9
    s_add_u32 m0, m0, s64
    s_add_u32 s54, s54, s65
    buffer_load_dwordx4 v15, s[48:51], s54 offen lds
    s_add_u32 s19, s19, 2326528
    s_add_u32 m0, m0, s64
    s_add_u32 s54, s54, s65
    buffer_load_dwordx4 v15, s[48:51], s54 offen lds
    s_add_u32 m0, m0, s64
    s_add_u32 s54, s54, s65
    buffer_load_dwordx4 v15, s[48:51], s54 offen lds
    s_add_u32 m0, m0, s64
    s_add_u32 s54, s54, s65
    buffer_load_dwordx4 v15, s[48:51], s54 offen lds
    s_add_u32 m0, m0, s66
    s_add_u32 s54, s54, s67
    buffer_load_dwordx4 v15, s[48:51], s54 offen lds
    s_add_u32 m0, m0, s64
    s_add_u32 s54, s54, s65
    buffer_load_dwordx4 v15, s[48:51], s54 offen lds
    s_add_u32 m0, m0, s64
    s_add_u32 s54, s54, s65
    buffer_load_dwordx4 v15, s[48:51], s54 offen lds
    s_add_u32 m0, m0, s64
    s_add_u32 s54, s54, s65
    buffer_load_dwordx4 v15, s[48:51], s54 offen lds
    s_add_u32 m0, m0, s64
    s_add_u32 s54, s54, s65
    buffer_load_dwordx4 v15, s[48:51], s54 offen lds
    s_add_u32 m0, m0, s68
    s_add_u32 s54, s54, s69
    buffer_load_dwordx4 v15, s[48:51], s54 offen lds
    s_add_u32 m0, m0, s64
    s_add_u32 s54, s54, s65
    buffer_load_dwordx4 v15, s[48:51], s54 offen lds
    s_add_u32 m0, m0, s64
    s_add_u32 s54, s54, s65
    buffer_load_dwordx4 v15, s[48:51], s54 offen lds
    s_add_u32 m0, m0, s64
    s_add_u32 s54, s54, s65
    buffer_load_dwordx4 v15, s[48:51], s54 offen lds
    s_add_u32 m0, m0, s64
    s_add_u32 s54, s54, s65
    buffer_load_dwordx4 v15, s[48:51], s54 offen lds
    s_add_u32 m0, m0, s64
    s_add_u32 s54, s54, s65
    buffer_load_dwordx4 v15, s[48:51], s54 offen lds
    s_add_u32 m0, m0, s64
    s_add_u32 s54, s54, s65
    buffer_load_dwordx4 v15, s[48:51], s54 offen lds
    s_add_u32 m0, m0, s64
    s_add_u32 s54, s54, s65
    buffer_load_dwordx4 v15, s[48:51], s54 offen lds
    s_add_u32 m0, m0, s64
    s_add_u32 s54, s54, s65
    buffer_load_dwordx4 v15, s[48:51], s54 offen lds
    s_add_u32 m0, m0, s64
    s_add_u32 s54, s54, s65
    buffer_load_dwordx4 v15, s[48:51], s54 offen lds
    s_add_u32 m0, m0, s64
    s_add_u32 s54, s54, s65
    buffer_load_dwordx4 v15, s[48:51], s54 offen lds
    s_cmp_lg_u32 s3, 1
    s_cbranch_scc1 PI_69
    s_mov_b32 s0, 0
    s_atomic_add s0, s[24:25], s39 glc
PI_69:
    s_waitcnt vmcnt(0)
    s_barrier
    s_cmp_lg_u32 s3, 1
    s_cbranch_scc1 PD_71
    s_mov_b32 s1, 0
PC_70:
    s_waitcnt lgkmcnt(0)
    s_cmp_ge_u32 s0, 28
    s_cbranch_scc1 PD_71
    s_add_u32 s1, s1, 1
    s_cmp_gt_u32 s1, 1048576
    s_cbranch_scc1 PD_71
    s_mov_b32 s0, 0
    s_atomic_add s0, s[24:25], s39 glc
    s_branch PC_70
PD_71:
    s_cmp_lg_u32 s3, 1
    s_cbranch_scc1 SD_V
    s_mov_b32 m0, 4096
    s_mov_b32 s6, 2258944
    buffer_load_dwordx4 v3, s[12:15], s6 offen sc1 lds
    s_mov_b32 m0, 4224
    s_nop 0
    buffer_load_dwordx4 v3, s[12:15], s6 offen offset:1024 sc1 lds
SD_V:
    ds_read_b64_tr_b16 a[0:1], v8 offset:0
    ds_read_b64_tr_b16 a[2:3], v8 offset:512
    ds_read_b64_tr_b16 a[4:5], v8 offset:2048
    ds_read_b64_tr_b16 a[6:7], v8 offset:2560
    ds_read_b64_tr_b16 a[8:9], v8 offset:4096
    ds_read_b64_tr_b16 a[10:11], v8 offset:4608
    ds_read_b64_tr_b16 a[12:13], v8 offset:6144
    ds_read_b64_tr_b16 a[14:15], v8 offset:6656
    ds_read_b64_tr_b16 a[16:17], v8 offset:8192
    ds_read_b64_tr_b16 a[18:19], v8 offset:8704
    ds_read_b64_tr_b16 a[20:21], v8 offset:10240
    ds_read_b64_tr_b16 a[22:23], v8 offset:10752
    ds_read_b64_tr_b16 a[24:25], v8 offset:12288
    ds_read_b64_tr_b16 a[26:27], v8 offset:12800
    ds_read_b64_tr_b16 a[28:29], v8 offset:14336
    ds_read_b64_tr_b16 a[30:31], v8 offset:14848
    ds_read_b64_tr_b16 a[32:33], v8 offset:16384
    ds_read_b64_tr_b16 a[34:35], v8 offset:16896
    ds_read_b64_tr_b16 a[36:37], v8 offset:18432
    ds_read_b64_tr_b16 a[38:39], v8 offset:18944
    ds_read_b64_tr_b16 a[40:41], v8 offset:20480
    ds_read_b64_tr_b16 a[42:43], v8 offset:20992
    ds_read_b64_tr_b16 a[44:45], v8 offset:22528
    ds_read_b64_tr_b16 a[46:47], v8 offset:23040
    ds_read_b64_tr_b16 a[48:49], v8 offset:24576
    ds_read_b64_tr_b16 a[50:51], v8 offset:25088
    ds_read_b64_tr_b16 a[52:53], v8 offset:26624
    ds_read_b64_tr_b16 a[54:55], v8 offset:27136
    ds_read_b64_tr_b16 a[56:57], v8 offset:28672
    ds_read_b64_tr_b16 a[58:59], v8 offset:29184
    ds_read_b64_tr_b16 a[60:61], v8 offset:30720
    ds_read_b64_tr_b16 a[62:63], v8 offset:31232
    ds_read_b64_tr_b16 a[64:65], v8 offset:32768
    ds_read_b64_tr_b16 a[66:67], v8 offset:33280
    ds_read_b64_tr_b16 a[68:69], v8 offset:34816
    ds_read_b64_tr_b16 a[70:71], v8 offset:35328
    ds_read_b64_tr_b16 a[72:73], v8 offset:36864
    ds_read_b64_tr_b16 a[74:75], v8 offset:37376
    ds_read_b64_tr_b16 a[76:77], v8 offset:38912
    ds_read_b64_tr_b16 a[78:79], v8 offset:39424
    ds_read_b64_tr_b16 a[80:81], v8 offset:40960
    ds_read_b64_tr_b16 a[82:83], v8 offset:41472
    ds_read_b64_tr_b16 a[84:85], v8 offset:43008
    ds_read_b64_tr_b16 a[86:87], v8 offset:43520
    ds_read_b64_tr_b16 a[88:89], v8 offset:45056
    ds_read_b64_tr_b16 a[90:91], v8 offset:45568
    ds_read_b64_tr_b16 a[92:93], v8 offset:47104
    ds_read_b64_tr_b16 a[94:95], v8 offset:47616
    ds_read_b64_tr_b16 a[96:97], v8 offset:49152
    ds_read_b64_tr_b16 a[98:99], v8 offset:49664
    ds_read_b64_tr_b16 a[100:101], v8 offset:51200
    ds_read_b64_tr_b16 a[102:103], v8 offset:51712
    ds_read_b64_tr_b16 a[104:105], v8 offset:53248
    ds_read_b64_tr_b16 a[106:107], v8 offset:53760
    ds_read_b64_tr_b16 a[108:109], v8 offset:55296
    ds_read_b64_tr_b16 a[110:111], v8 offset:55808
    s_waitcnt vmcnt(0)
    s_barrier
    ds_read_b128 v[16:19], v9 offset:4096
    ds_read_b128 v[20:23], v9 offset:4128
    ds_read_b128 v[24:27], v9 offset:4160
    ds_read_b128 v[28:31], v9 offset:4192
    ds_read_b128 v[32:35], v9 offset:4224
    ds_read_b128 v[36:39], v9 offset:4256
    s_waitcnt lgkmcnt(5)
    v_mfma_f32_32x32x16_bf16 v[240:255], v[16:19], a[0:3], 0
    ds_read_b128 v[40:43], v9 offset:4288
    s_waitcnt lgkmcnt(5)
    v_mfma_f32_32x32x16_bf16 v[240:255], v[20:23], a[4:7], v[240:255]
    ds_read_b128 v[44:47], v9 offset:4320
    s_waitcnt lgkmcnt(5)
    v_mfma_f32_32x32x16_bf16 v[240:255], v[24:27], a[8:11], v[240:255]
    ds_read_b128 v[48:51], v9 offset:4352
    s_waitcnt lgkmcnt(5)
    v_mfma_f32_32x32x16_bf16 v[240:255], v[28:31], a[12:15], v[240:255]
    ds_read_b128 v[52:55], v9 offset:4384
    s_waitcnt lgkmcnt(5)
    v_mfma_f32_32x32x16_bf16 v[240:255], v[32:35], a[16:19], v[240:255]
    ds_read_b128 v[56:59], v9 offset:4416
    s_waitcnt lgkmcnt(5)
    v_mfma_f32_32x32x16_bf16 v[240:255], v[36:39], a[20:23], v[240:255]
    ds_read_b128 v[60:63], v9 offset:4448
    s_waitcnt lgkmcnt(5)
    v_mfma_f32_32x32x16_bf16 v[240:255], v[40:43], a[24:27], v[240:255]
    ds_read_b128 v[64:67], v9 offset:4480
    s_waitcnt lgkmcnt(5)
    v_mfma_f32_32x32x16_bf16 v[240:255], v[44:47], a[28:31], v[240:255]
    ds_read_b128 v[68:71], v9 offset:4512
    s_waitcnt lgkmcnt(5)
    v_mfma_f32_32x32x16_bf16 v[240:255], v[48:51], a[32:35], v[240:255]
    ds_read_b128 v[72:75], v9 offset:4544
    s_waitcnt lgkmcnt(5)
    v_mfma_f32_32x32x16_bf16 v[240:255], v[52:55], a[36:39], v[240:255]
    ds_read_b128 v[76:79], v9 offset:4576
    s_waitcnt lgkmcnt(5)
    v_mfma_f32_32x32x16_bf16 v[240:255], v[56:59], a[40:43], v[240:255]
    ds_read_b128 v[80:83], v9 offset:4608
    s_waitcnt lgkmcnt(5)
    v_mfma_f32_32x32x16_bf16 v[240:255], v[60:63], a[44:47], v[240:255]
    ds_read_b128 v[84:87], v9 offset:4640
    s_waitcnt lgkmcnt(5)
    v_mfma_f32_32x32x16_bf16 v[240:255], v[64:67], a[48:51], v[240:255]
    ds_read_b128 v[88:91], v9 offset:4672
    s_waitcnt lgkmcnt(5)
    v_mfma_f32_32x32x16_bf16 v[240:255], v[68:71], a[52:55], v[240:255]
    ds_read_b128 v[92:95], v9 offset:4704
    s_waitcnt lgkmcnt(5)
    v_mfma_f32_32x32x16_bf16 v[240:255], v[72:75], a[56:59], v[240:255]
    ds_read_b128 v[96:99], v9 offset:4736
    s_waitcnt lgkmcnt(5)
    v_mfma_f32_32x32x16_bf16 v[240:255], v[76:79], a[60:63], v[240:255]
    ds_read_b128 v[100:103], v9 offset:4768
    s_waitcnt lgkmcnt(5)
    v_mfma_f32_32x32x16_bf16 v[240:255], v[80:83], a[64:67], v[240:255]
    ds_read_b128 v[104:107], v9 offset:4800
    s_waitcnt lgkmcnt(5)
    v_mfma_f32_32x32x16_bf16 v[240:255], v[84:87], a[68:71], v[240:255]
    ds_read_b128 v[108:111], v9 offset:4832
    s_waitcnt lgkmcnt(5)
    v_mfma_f32_32x32x16_bf16 v[240:255], v[88:91], a[72:75], v[240:255]
    ds_read_b128 v[112:115], v9 offset:4864
    s_waitcnt lgkmcnt(5)
    v_mfma_f32_32x32x16_bf16 v[240:255], v[92:95], a[76:79], v[240:255]
    ds_read_b128 v[116:119], v9 offset:4896
    s_waitcnt lgkmcnt(5)
    v_mfma_f32_32x32x16_bf16 v[240:255], v[96:99], a[80:83], v[240:255]
    ds_read_b128 v[120:123], v9 offset:4928
    s_waitcnt lgkmcnt(5)
    v_mfma_f32_32x32x16_bf16 v[240:255], v[100:103], a[84:87], v[240:255]
    ds_read_b128 v[124:127], v9 offset:4960
    s_waitcnt lgkmcnt(5)
    v_mfma_f32_32x32x16_bf16 v[240:255], v[104:107], a[88:91], v[240:255]
    s_waitcnt lgkmcnt(4)
    v_mfma_f32_32x32x16_bf16 v[240:255], v[108:111], a[92:95], v[240:255]
    s_waitcnt lgkmcnt(3)
    v_mfma_f32_32x32x16_bf16 v[240:255], v[112:115], a[96:99], v[240:255]
    s_waitcnt lgkmcnt(2)
    v_mfma_f32_32x32x16_bf16 v[240:255], v[116:119], a[100:103], v[240:255]
    s_waitcnt lgkmcnt(1)
    v_mfma_f32_32x32x16_bf16 v[240:255], v[120:123], a[104:107], v[240:255]
    s_waitcnt lgkmcnt(0)
    v_mfma_f32_32x32x16_bf16 v[240:255], v[124:127], a[108:111], v[240:255]
    s_nop 11
    v_cvt_pk_bf16_f32 v9, v240, v241
    v_lshlrev_b32 v12, 16, v9
    v_and_b32 v13, 0xffff0000, v9
    v_sub_f32 v12, v240, v12
    v_sub_f32 v13, v241, v13
    v_cvt_pk_bf16_f32 v8, v240, v12
    v_cvt_pk_bf16_f32 v10, v13, v241
    v_mov_b32 v11, 0
    s_mov_b32 exec_hi, 0
    buffer_store_dwordx4 v[8:11], v3, s[12:15], s19 offen sc1
    s_mov_b32 exec_hi, -1
    s_waitcnt vmcnt(0)
    s_barrier
    s_cmp_lg_u32 s3, 0
    s_cbranch_scc1 SIG_72
    s_mov_b32 s74, 1
    s_atomic_add s74, s[24:25], s38
SIG_72:
    s_endpgm
    .p2align 12
SD_Z:
    v_lshrrev_b32 v1, 6, v0
    v_and_b32 v2, 63, v0
    v_readfirstlane_b32 s3, v1
    v_lshrrev_b32 v6, 3, v2
    v_and_b32 v8, 7, v2
    s_mul_i32 s39, s3, 112
    v_add_u32 v7, s39, v6
    v_mul_u32_u24 v7, 5376, v7
    v_lshl_add_u32 v7, v8, 4, v7
    s_mul_i32 s62, s33, 0
    v_add_u32 v9, s62, v2
    v_add_u32 v11, 56, v9
    v_subrev_u32 v10, 112, v9
    v_min_u32 v9, v9, v10
    v_subrev_u32 v10, 112, v11
    v_min_u32 v11, v11, v10
    v_add_lshl_u32 v9, v9, s39, 1
    v_add_lshl_u32 v11, v11, s39, 1
    s_mul_i32 s62, s62, 5376
    s_mov_b32 s10, 2408448
    s_mov_b32 s11, 0x20000
    s_mov_b32 s46, 896
    s_mov_b32 s47, 0x20000
    s_mov_b32 s14, 15302656
    s_mov_b32 s15, 0x20000
    s_lshl_b32 s34, s33, 1
    s_add_u32 s35, s34, 1
    s_lshl_b32 s40, s34, 7
    s_lshl_b32 s41, s35, 7
    s_cmp_eq_u32 s33, 3
    s_cselect_b32 s41, 0x7ff00000, s41
    v_lshlrev_b32 v3, 4, v2
    v_and_b32 v4, 31, v2
    v_lshrrev_b32 v5, 5, v2
    s_and_b32 s42, s3, 1
    s_lshr_b32 s43, s3, 1
    s_mov_b32 s52, 0x3b124925
    s_mov_b32 s53, 0xc3e00000
    s_waitcnt lgkmcnt(0)
    s_mov_b32 s44, s22
    s_and_b32 s45, s23, 0xffff
    s_mov_b32 s8, s24
    s_and_b32 s9, s25, 0xffff
    s_mov_b32 s12, s30
    s_and_b32 s13, s31, 0xffff
    s_cmp_lg_u32 s2, 31
    s_cbranch_scc1 SD_NZ
    v_lshlrev_b32 v10, 4, v0
    v_mov_b64 v[16:17], 0
    v_mov_b64 v[18:19], 0
    s_mov_b32 s6, 2281472
    buffer_store_dwordx4 v[16:19], v10, s[12:15], s6 offen sc1
    s_add_u32 s6, s6, 4096
    buffer_store_dwordx4 v[16:19], v10, s[12:15], s6 offen sc1
    s_add_u32 s6, s6, 4096
    buffer_store_dwordx4 v[16:19], v10, s[12:15], s6 offen sc1
    s_add_u32 s6, s6, 4096
    buffer_store_dwordx4 v[16:19], v10, s[12:15], s6 offen sc1
    s_add_u32 s6, s6, 4096
    s_mov_b32 s74, 1
    s_waitcnt vmcnt(0)
    s_barrier
    s_cmp_lg_u32 s3, 0
    s_cbranch_scc1 SD_NZ
    s_atomic_or s74, s[28:29], 0x0
SD_NZ:
    buffer_load_ushort v10, v9, s[44:47], 0 offen
    buffer_load_ushort v11, v11, s[44:47], 0 offen
    s_add_u32 s63, s62, s40
    buffer_load_dwordx4 v[16:19], v7, s[8:11], s63 offen
    s_add_u32 s62, s62, 43008
    s_add_u32 s63, s62, s40
    buffer_load_dwordx4 v[20:23], v7, s[8:11], s63 offen
    v_lshlrev_b32 v150, 3, v8
    v_add_u32 v150, v150, v6
    v_lshlrev_b32 v150, 2, v150
    s_lshl_b32 s57, s3, 8
    v_add_u32 v9, s57, v150
    v_lshlrev_b32 v241, 2, v2
    v_lshlrev_b32 v244, 2, v6
    v_mov_b32 v245, 0
    v_mov_b64 v[142:143], 0
    v_mov_b64 v[144:145], 0
    v_mov_b64 v[146:147], 0
    v_mov_b64 v[148:149], 0
    v_cvt_f32_u32 v151, v0
    s_lshl_b32 s6, s33, 7
    s_add_u32 s62, s62, 43008
    s_add_u32 s63, s62, s40
    buffer_load_dwordx4 v[24:27], v7, s[8:11], s63 offen
    v_cvt_f32_u32 v150, s6
    v_mul_f32 v13, v151, v150
    v_mul_f32 v14, s52, v13
    v_floor_f32 v14, v14
    v_fma_f32 v13, v14, s53, v13
    v_fma_f32 v13, v13, s52, 0
    v_mul_f32 v14, s52, v151
    v_add_f32 v150, 0x42800000, v150
    v_fmamk_f32 v152, v14, 0x00000000, v13
    v_fmamk_f32 v153, v14, 0x3f800000, v13
    v_fmamk_f32 v154, v14, 0x40000000, v13
    v_fmamk_f32 v155, v14, 0x40400000, v13
    v_cos_f32 v152, v152
    s_add_u32 s62, s62, 43008
    s_add_u32 s63, s62, s40
    buffer_load_dwordx4 v[28:31], v7, s[8:11], s63 offen
    v_cos_f32 v153, v153
    v_cos_f32 v154, v154
    v_cos_f32 v155, v155
    v_cvt_pk_bf16_f32 v176, v152, v153
    v_cvt_pk_bf16_f32 v177, v154, v155
    v_fmamk_f32 v152, v14, 0x40800000, v13
    v_fmamk_f32 v153, v14, 0x40a00000, v13
    v_fmamk_f32 v154, v14, 0x40c00000, v13
    v_fmamk_f32 v155, v14, 0x40e00000, v13
    v_cos_f32 v152, v152
    s_add_u32 s62, s62, 43008
    s_add_u32 s63, s62, s40
    buffer_load_dwordx4 v[32:35], v7, s[8:11], s63 offen
    v_cos_f32 v153, v153
    v_cos_f32 v154, v154
    v_cos_f32 v155, v155
    v_cvt_pk_bf16_f32 v178, v152, v153
    v_cvt_pk_bf16_f32 v179, v154, v155
    v_fmamk_f32 v152, v14, 0x41000000, v13
    v_fmamk_f32 v153, v14, 0x41100000, v13
    v_fmamk_f32 v154, v14, 0x41200000, v13
    v_fmamk_f32 v155, v14, 0x41300000, v13
    v_cos_f32 v152, v152
    s_add_u32 s62, s62, 43008
    s_add_u32 s63, s62, s40
    buffer_load_dwordx4 v[36:39], v7, s[8:11], s63 offen
    v_cos_f32 v153, v153
    v_cos_f32 v154, v154
    v_cos_f32 v155, v155
    v_cvt_pk_bf16_f32 v180, v152, v153
    v_cvt_pk_bf16_f32 v181, v154, v155
    v_fmamk_f32 v152, v14, 0x41400000, v13
    v_fmamk_f32 v153, v14, 0x41500000, v13
    v_fmamk_f32 v154, v14, 0x41600000, v13
    v_fmamk_f32 v155, v14, 0x41700000, v13
    v_cos_f32 v152, v152
    s_add_u32 s62, s62, 43008
    s_add_u32 s63, s62, s40
    buffer_load_dwordx4 v[40:43], v7, s[8:11], s63 offen
    v_cos_f32 v153, v153
    v_cos_f32 v154, v154
    v_cos_f32 v155, v155
    v_cvt_pk_bf16_f32 v182, v152, v153
    v_cvt_pk_bf16_f32 v183, v154, v155
    v_fmamk_f32 v152, v14, 0x41800000, v13
    v_fmamk_f32 v153, v14, 0x41880000, v13
    v_fmamk_f32 v154, v14, 0x41900000, v13
    v_fmamk_f32 v155, v14, 0x41980000, v13
    v_cos_f32 v152, v152
    s_add_u32 s62, s62, 43008
    s_add_u32 s63, s62, s40
    buffer_load_dwordx4 v[44:47], v7, s[8:11], s63 offen
    v_cos_f32 v153, v153
    v_cos_f32 v154, v154
    v_cos_f32 v155, v155
    v_cvt_pk_bf16_f32 v184, v152, v153
    v_cvt_pk_bf16_f32 v185, v154, v155
    v_fmamk_f32 v152, v14, 0x41a00000, v13
    v_fmamk_f32 v153, v14, 0x41a80000, v13
    v_fmamk_f32 v154, v14, 0x41b00000, v13
    v_fmamk_f32 v155, v14, 0x41b80000, v13
    v_cos_f32 v152, v152
    s_add_u32 s62, s62, 43008
    s_add_u32 s63, s62, s40
    buffer_load_dwordx4 v[48:51], v7, s[8:11], s63 offen
    v_cos_f32 v153, v153
    v_cos_f32 v154, v154
    v_cos_f32 v155, v155
    v_cvt_pk_bf16_f32 v186, v152, v153
    v_cvt_pk_bf16_f32 v187, v154, v155
    v_fmamk_f32 v152, v14, 0x41c00000, v13
    v_fmamk_f32 v153, v14, 0x41c80000, v13
    v_fmamk_f32 v154, v14, 0x41d00000, v13
    v_fmamk_f32 v155, v14, 0x41d80000, v13
    v_cos_f32 v152, v152
    s_add_u32 s62, s62, 43008
    s_add_u32 s63, s62, s40
    buffer_load_dwordx4 v[52:55], v7, s[8:11], s63 offen
    v_cos_f32 v153, v153
    v_cos_f32 v154, v154
    v_cos_f32 v155, v155
    v_cvt_pk_bf16_f32 v188, v152, v153
    v_cvt_pk_bf16_f32 v189, v154, v155
    v_fmamk_f32 v152, v14, 0x41e00000, v13
    v_fmamk_f32 v153, v14, 0x41e80000, v13
    v_fmamk_f32 v154, v14, 0x41f00000, v13
    v_fmamk_f32 v155, v14, 0x41f80000, v13
    v_cos_f32 v152, v152
    v_cos_f32 v153, v153
    v_cos_f32 v154, v154
    v_cos_f32 v155, v155
    v_cvt_pk_bf16_f32 v190, v152, v153
    v_cvt_pk_bf16_f32 v191, v154, v155
    v_fmamk_f32 v152, v14, 0x42000000, v13
    v_fmamk_f32 v153, v14, 0x42040000, v13
    v_fmamk_f32 v154, v14, 0x42080000, v13
    v_fmamk_f32 v155, v14, 0x420c0000, v13
    v_cos_f32 v152, v152
    v_cos_f32 v153, v153
    v_cos_f32 v154, v154
    v_cos_f32 v155, v155
    v_cvt_pk_bf16_f32 v192, v152, v153
    v_cvt_pk_bf16_f32 v193, v154, v155
    v_fmamk_f32 v152, v14, 0x42100000, v13
    v_fmamk_f32 v153, v14, 0x42140000, v13
    v_fmamk_f32 v154, v14, 0x42180000, v13
    v_fmamk_f32 v155, v14, 0x421c0000, v13
    v_cos_f32 v152, v152
    v_cos_f32 v153, v153
    v_cos_f32 v154, v154
    v_cos_f32 v155, v155
    v_cvt_pk_bf16_f32 v194, v152, v153
    v_cvt_pk_bf16_f32 v195, v154, v155
    v_fmamk_f32 v152, v14, 0x42200000, v13
    v_fmamk_f32 v153, v14, 0x42240000, v13
    v_fmamk_f32 v154, v14, 0x42280000, v13
    v_fmamk_f32 v155, v14, 0x422c0000, v13
    v_cos_f32 v152, v152
    v_cos_f32 v153, v153
    v_cos_f32 v154, v154
    v_cos_f32 v155, v155
    v_cvt_pk_bf16_f32 v196, v152, v153
    v_cvt_pk_bf16_f32 v197, v154, v155
    v_fmamk_f32 v152, v14, 0x42300000, v13
    v_fmamk_f32 v153, v14, 0x42340000, v13
    v_fmamk_f32 v154, v14, 0x42380000, v13
    v_fmamk_f32 v155, v14, 0x423c0000, v13
    v_cos_f32 v152, v152
    v_cos_f32 v153, v153
    v_cos_f32 v154, v154
    v_cos_f32 v155, v155
    v_cvt_pk_bf16_f32 v198, v152, v153
    v_cvt_pk_bf16_f32 v199, v154, v155
    v_fmamk_f32 v152, v14, 0x42400000, v13
    v_fmamk_f32 v153, v14, 0x42440000, v13
    v_fmamk_f32 v154, v14, 0x42480000, v13
    v_fmamk_f32 v155, v14, 0x424c0000, v13
    v_cos_f32 v152, v152
    v_cos_f32 v153, v153
    v_cos_f32 v154, v154
    v_cos_f32 v155, v155
    v_cvt_pk_bf16_f32 v200, v152, v153
    v_cvt_pk_bf16_f32 v201, v154, v155
    v_fmamk_f32 v152, v14, 0x42500000, v13
    v_fmamk_f32 v153, v14, 0x42540000, v13
    v_fmamk_f32 v154, v14, 0x42580000, v13
    v_fmamk_f32 v155, v14, 0x425c0000, v13
    v_cos_f32 v152, v152
    v_cos_f32 v153, v153
    v_cos_f32 v154, v154
    v_cos_f32 v155, v155
    v_cvt_pk_bf16_f32 v202, v152, v153
    v_cvt_pk_bf16_f32 v203, v154, v155
    v_fmamk_f32 v152, v14, 0x42600000, v13
    v_fmamk_f32 v153, v14, 0x42640000, v13
    v_fmamk_f32 v154, v14, 0x42680000, v13
    v_fmamk_f32 v155, v14, 0x426c0000, v13
    v_cos_f32 v152, v152
    v_cos_f32 v153, v153
    v_cos_f32 v154, v154
    v_cos_f32 v155, v155
    v_cvt_pk_bf16_f32 v204, v152, v153
    v_cvt_pk_bf16_f32 v205, v154, v155
    v_fmamk_f32 v152, v14, 0x42700000, v13
    v_fmamk_f32 v153, v14, 0x42740000, v13
    v_fmamk_f32 v154, v14, 0x42780000, v13
    v_fmamk_f32 v155, v14, 0x427c0000, v13
    v_cos_f32 v152, v152
    v_cos_f32 v153, v153
    v_cos_f32 v154, v154
    v_cos_f32 v155, v155
    v_cvt_pk_bf16_f32 v206, v152, v153
    v_cvt_pk_bf16_f32 v207, v154, v155
    v_mul_f32 v13, v151, v150
    v_mul_f32 v14, s52, v13
    v_floor_f32 v14, v14
    v_fma_f32 v13, v14, s53, v13
    v_fma_f32 v13, v13, s52, 0
    v_mul_f32 v14, s52, v151
    v_add_f32 v150, 0x42800000, v150
    v_fmamk_f32 v152, v14, 0x00000000, v13
    v_fmamk_f32 v153, v14, 0x3f800000, v13
    v_fmamk_f32 v154, v14, 0x40000000, v13
    v_fmamk_f32 v155, v14, 0x40400000, v13
    v_cos_f32 v152, v152
    v_cos_f32 v153, v153
    v_cos_f32 v154, v154
    v_cos_f32 v155, v155
    v_cvt_pk_bf16_f32 v208, v152, v153
    v_cvt_pk_bf16_f32 v209, v154, v155
    v_fmamk_f32 v152, v14, 0x40800000, v13
    v_fmamk_f32 v153, v14, 0x40a00000, v13
    v_fmamk_f32 v154, v14, 0x40c00000, v13
    v_fmamk_f32 v155, v14, 0x40e00000, v13
    v_cos_f32 v152, v152
    v_cos_f32 v153, v153
    v_cos_f32 v154, v154
    v_cos_f32 v155, v155
    v_cvt_pk_bf16_f32 v210, v152, v153
    v_cvt_pk_bf16_f32 v211, v154, v155
    v_fmamk_f32 v152, v14, 0x41000000, v13
    v_fmamk_f32 v153, v14, 0x41100000, v13
    v_fmamk_f32 v154, v14, 0x41200000, v13
    v_fmamk_f32 v155, v14, 0x41300000, v13
    v_cos_f32 v152, v152
    v_cos_f32 v153, v153
    v_cos_f32 v154, v154
    v_cos_f32 v155, v155
    v_cvt_pk_bf16_f32 v212, v152, v153
    v_cvt_pk_bf16_f32 v213, v154, v155
    v_fmamk_f32 v152, v14, 0x41400000, v13
    v_fmamk_f32 v153, v14, 0x41500000, v13
    v_fmamk_f32 v154, v14, 0x41600000, v13
    v_fmamk_f32 v155, v14, 0x41700000, v13
    v_cos_f32 v152, v152
    v_cos_f32 v153, v153
    v_cos_f32 v154, v154
    v_cos_f32 v155, v155
    v_cvt_pk_bf16_f32 v214, v152, v153
    v_cvt_pk_bf16_f32 v215, v154, v155
    v_fmamk_f32 v152, v14, 0x41800000, v13
    v_fmamk_f32 v153, v14, 0x41880000, v13
    v_fmamk_f32 v154, v14, 0x41900000, v13
    s_waitcnt vmcnt(10)
    v_lshlrev_b32 v10, 16, v10
    v_lshlrev_b32 v11, 16, v11
    v_mul_f32 v246, 0xbfb8aa3b, v10
    v_mul_f32 v247, 0xbfb8aa3b, v11
    v_exp_f32 v246, v246
    v_exp_f32 v247, v247
    v_add_f32 v246, 1.0, v246
    v_add_f32 v247, 1.0, v247
    v_rcp_f32 v246, v246
    v_rcp_f32 v247, v247
    v_mul_f32 v10, v10, v246
    v_mul_f32 v11, v11, v247
    v_cvt_pk_bf16_f32 v10, v10, v245
    v_cvt_pk_bf16_f32 v11, v11, v245
    ds_bpermute_b32 v128, v244, v10 offset:0
    ds_bpermute_b32 v129, v244, v10 offset:32
    ds_bpermute_b32 v130, v244, v10 offset:64
    ds_bpermute_b32 v131, v244, v10 offset:96
    ds_bpermute_b32 v132, v244, v10 offset:128
    ds_bpermute_b32 v133, v244, v10 offset:160
    ds_bpermute_b32 v134, v244, v10 offset:192
    ds_bpermute_b32 v135, v244, v11 offset:0
    ds_bpermute_b32 v136, v244, v11 offset:32
    ds_bpermute_b32 v137, v244, v11 offset:64
    ds_bpermute_b32 v138, v244, v11 offset:96
    ds_bpermute_b32 v139, v244, v11 offset:128
    ds_bpermute_b32 v140, v244, v11 offset:160
    ds_bpermute_b32 v141, v244, v11 offset:192
    s_add_u32 s62, s62, 43008
    s_add_u32 s63, s62, s40
    buffer_load_dwordx4 v[56:59], v7, s[8:11], s63 offen
    s_add_u32 s62, s62, 43008
    s_add_u32 s63, s62, s40
    buffer_load_dwordx4 v[60:63], v7, s[8:11], s63 offen
    v_fmamk_f32 v155, v14, 0x41980000, v13
    v_cos_f32 v152, v152
    v_cos_f32 v153, v153
    v_cos_f32 v154, v154
    v_cos_f32 v155, v155
    v_cvt_pk_bf16_f32 v216, v152, v153
    v_cvt_pk_bf16_f32 v217, v154, v155
    v_fmamk_f32 v152, v14, 0x41a00000, v13
    v_fmamk_f32 v153, v14, 0x41a80000, v13
    v_fmamk_f32 v154, v14, 0x41b00000, v13
    v_fmamk_f32 v155, v14, 0x41b80000, v13
    v_cos_f32 v152, v152
    s_add_u32 s62, s62, 43008
    s_add_u32 s63, s62, s40
    buffer_load_dwordx4 v[64:67], v7, s[8:11], s63 offen
    v_cos_f32 v153, v153
    v_cos_f32 v154, v154
    v_cos_f32 v155, v155
    v_cvt_pk_bf16_f32 v218, v152, v153
    v_cvt_pk_bf16_f32 v219, v154, v155
    v_fmamk_f32 v152, v14, 0x41c00000, v13
    v_fmamk_f32 v153, v14, 0x41c80000, v13
    v_fmamk_f32 v154, v14, 0x41d00000, v13
    v_fmamk_f32 v155, v14, 0x41d80000, v13
    v_cos_f32 v152, v152
    v_cos_f32 v153, v153
    s_add_u32 s62, s62, 43008
    s_add_u32 s63, s62, s40
    buffer_load_dwordx4 v[68:71], v7, s[8:11], s63 offen
    v_cos_f32 v154, v154
    v_cos_f32 v155, v155
    v_cvt_pk_bf16_f32 v220, v152, v153
    v_cvt_pk_bf16_f32 v221, v154, v155
    v_fmamk_f32 v152, v14, 0x41e00000, v13
    v_fmamk_f32 v153, v14, 0x41e80000, v13
    v_fmamk_f32 v154, v14, 0x41f00000, v13
    v_fmamk_f32 v155, v14, 0x41f80000, v13
    v_cos_f32 v152, v152
    v_cos_f32 v153, v153
    v_cos_f32 v154, v154
    s_add_u32 s62, s62, 43008
    s_cmp_eq_u32 s62, 602112
    s_cselect_b32 s62, 0, s62
    s_add_u32 s63, s62, s41
    buffer_load_dwordx4 v[72:75], v7, s[8:11], s63 offen
    v_cos_f32 v155, v155
    v_cvt_pk_bf16_f32 v222, v152, v153
    v_cvt_pk_bf16_f32 v223, v154, v155
    v_fmamk_f32 v152, v14, 0x42000000, v13
    v_fmamk_f32 v153, v14, 0x42040000, v13
    v_fmamk_f32 v154, v14, 0x42080000, v13
    v_fmamk_f32 v155, v14, 0x420c0000, v13
    v_cos_f32 v152, v152
    v_cos_f32 v153, v153
    v_cos_f32 v154, v154
    v_cos_f32 v155, v155
    s_add_u32 s62, s62, 43008
    s_add_u32 s63, s62, s41
    buffer_load_dwordx4 v[76:79], v7, s[8:11], s63 offen
    v_cvt_pk_bf16_f32 v224, v152, v153
    v_cvt_pk_bf16_f32 v225, v154, v155
    v_fmamk_f32 v152, v14, 0x42100000, v13
    v_fmamk_f32 v153, v14, 0x42140000, v13
    v_fmamk_f32 v154, v14, 0x42180000, v13
    v_fmamk_f32 v155, v14, 0x421c0000, v13
    v_cos_f32 v152, v152
    v_cos_f32 v153, v153
    v_cos_f32 v154, v154
    v_cos_f32 v155, v155
    v_cvt_pk_bf16_f32 v226, v152, v153
    s_add_u32 s62, s62, 43008
    s_add_u32 s63, s62, s41
    buffer_load_dwordx4 v[80:83], v7, s[8:11], s63 offen
    v_cvt_pk_bf16_f32 v227, v154, v155
    v_fmamk_f32 v152, v14, 0x42200000, v13
    v_fmamk_f32 v153, v14, 0x42240000, v13
    v_fmamk_f32 v154, v14, 0x42280000, v13
    v_fmamk_f32 v155, v14, 0x422c0000, v13
    v_cos_f32 v152, v152
    v_cos_f32 v153, v153
    v_cos_f32 v154, v154
    v_cos_f32 v155, v155
    v_cvt_pk_bf16_f32 v228, v152, v153
    v_cvt_pk_bf16_f32 v229, v154, v155
    v_fmamk_f32 v152, v14, 0x42300000, v13
    s_add_u32 s62, s62, 43008
    s_add_u32 s63, s62, s41
    buffer_load_dwordx4 v[84:87], v7, s[8:11], s63 offen
    v_fmamk_f32 v153, v14, 0x42340000, v13
    v_fmamk_f32 v154, v14, 0x42380000, v13
    v_fmamk_f32 v155, v14, 0x423c0000, v13
    v_cos_f32 v152, v152
    v_cos_f32 v153, v153
    v_cos_f32 v154, v154
    v_cos_f32 v155, v155
    v_cvt_pk_bf16_f32 v230, v152, v153
    v_cvt_pk_bf16_f32 v231, v154, v155
    v_fmamk_f32 v152, v14, 0x42400000, v13
    v_fmamk_f32 v153, v14, 0x42440000, v13
    v_fmamk_f32 v154, v14, 0x42480000, v13
    s_add_u32 s62, s62, 43008
    s_add_u32 s63, s62, s41
    buffer_load_dwordx4 v[88:91], v7, s[8:11], s63 offen
    v_fmamk_f32 v155, v14, 0x424c0000, v13
    v_cos_f32 v152, v152
    v_cos_f32 v153, v153
    v_cos_f32 v154, v154
    v_cos_f32 v155, v155
    v_cvt_pk_bf16_f32 v232, v152, v153
    v_cvt_pk_bf16_f32 v233, v154, v155
    v_fmamk_f32 v152, v14, 0x42500000, v13
    v_fmamk_f32 v153, v14, 0x42540000, v13
    v_fmamk_f32 v154, v14, 0x42580000, v13
    v_fmamk_f32 v155, v14, 0x425c0000, v13
    v_cos_f32 v152, v152
    s_add_u32 s62, s62, 43008
    s_add_u32 s63, s62, s41
    buffer_load_dwordx4 v[92:95], v7, s[8:11], s63 offen
    v_cos_f32 v153, v153
    v_cos_f32 v154, v154
    v_cos_f32 v155, v155
    v_cvt_pk_bf16_f32 v234, v152, v153
    v_cvt_pk_bf16_f32 v235, v154, v155
    v_fmamk_f32 v152, v14, 0x42600000, v13
    v_fmamk_f32 v153, v14, 0x42640000, v13
    v_fmamk_f32 v154, v14, 0x42680000, v13
    v_fmamk_f32 v155, v14, 0x426c0000, v13
    v_cos_f32 v152, v152
    v_cos_f32 v153, v153
    s_add_u32 s62, s62, 43008
    s_add_u32 s63, s62, s41
    buffer_load_dwordx4 v[96:99], v7, s[8:11], s63 offen
    v_cos_f32 v154, v154
    v_cos_f32 v155, v155
    v_cvt_pk_bf16_f32 v236, v152, v153
    v_cvt_pk_bf16_f32 v237, v154, v155
    v_fmamk_f32 v152, v14, 0x42700000, v13
    v_fmamk_f32 v153, v14, 0x42740000, v13
    v_fmamk_f32 v154, v14, 0x42780000, v13
    v_fmamk_f32 v155, v14, 0x427c0000, v13
    v_cos_f32 v152, v152
    v_cos_f32 v153, v153
    v_cos_f32 v154, v154
    s_add_u32 s62, s62, 43008
    s_add_u32 s63, s62, s41
    buffer_load_dwordx4 v[100:103], v7, s[8:11], s63 offen
    v_cos_f32 v155, v155
    v_cvt_pk_bf16_f32 v238, v152, v153
    v_cvt_pk_bf16_f32 v239, v154, v155
    s_add_u32 s62, s62, 43008
    s_add_u32 s63, s62, s41
    buffer_load_dwordx4 v[104:107], v7, s[8:11], s63 offen
    s_waitcnt vmcnt(22) lgkmcnt(13)
    s_add_u32 s62, s62, 43008
    s_add_u32 s63, s62, s41
    buffer_load_dwordx4 v[108:111], v7, s[8:11], s63 offen
    v_lshlrev_b32 v150, 16, v128
    v_dot2_f32_bf16 v142, v16, v128, v142
    v_dot2_f32_bf16 v144, v17, v128, v144
    v_dot2_f32_bf16 v146, v18, v128, v146
    v_dot2_f32_bf16 v148, v19, v128, v148
    v_dot2_f32_bf16 v143, v16, v150, v143
    v_dot2_f32_bf16 v145, v17, v150, v145
    v_dot2_f32_bf16 v147, v18, v150, v147
    v_dot2_f32_bf16 v149, v19, v150, v149
    s_waitcnt vmcnt(22) lgkmcnt(12)
    s_add_u32 s62, s62, 43008
    s_add_u32 s63, s62, s41
    buffer_load_dwordx4 v[112:115], v7, s[8:11], s63 offen
    v_lshlrev_b32 v150, 16, v129
    v_dot2_f32_bf16 v142, v20, v129, v142
    v_dot2_f32_bf16 v144, v21, v129, v144
    v_dot2_f32_bf16 v146, v22, v129, v146
    v_dot2_f32_bf16 v148, v23, v129, v148
    v_dot2_f32_bf16 v143, v20, v150, v143
    v_dot2_f32_bf16 v145, v21, v150, v145
    v_dot2_f32_bf16 v147, v22, v150, v147
    v_dot2_f32_bf16 v149, v23, v150, v149
    s_waitcnt vmcnt(22) lgkmcnt(11)
    s_add_u32 s62, s62, 43008
    s_add_u32 s63, s62, s41
    buffer_load_dwordx4 v[116:119], v7, s[8:11], s63 offen
    v_lshlrev_b32 v150, 16, v130
    v_dot2_f32_bf16 v142, v24, v130, v142
    v_dot2_f32_bf16 v144, v25, v130, v144
    v_dot2_f32_bf16 v146, v26, v130, v146
    v_dot2_f32_bf16 v148, v27, v130, v148
    v_dot2_f32_bf16 v143, v24, v150, v143
    v_dot2_f32_bf16 v145, v25, v150, v145
    v_dot2_f32_bf16 v147, v26, v150, v147
    v_dot2_f32_bf16 v149, v27, v150, v149
    s_waitcnt vmcnt(22) lgkmcnt(10)
    s_add_u32 s62, s62, 43008
    s_add_u32 s63, s62, s41
    buffer_load_dwordx4 v[120:123], v7, s[8:11], s63 offen
    v_lshlrev_b32 v150, 16, v131
    v_dot2_f32_bf16 v142, v28, v131, v142
    v_dot2_f32_bf16 v144, v29, v131, v144
    v_dot2_f32_bf16 v146, v30, v131, v146
    v_dot2_f32_bf16 v148, v31, v131, v148
    v_dot2_f32_bf16 v143, v28, v150, v143
    v_dot2_f32_bf16 v145, v29, v150, v145
    v_dot2_f32_bf16 v147, v30, v150, v147
    v_dot2_f32_bf16 v149, v31, v150, v149
    s_waitcnt vmcnt(22) lgkmcnt(9)
    s_add_u32 s62, s62, 43008
    s_add_u32 s63, s62, s41
    buffer_load_dwordx4 v[124:127], v7, s[8:11], s63 offen
    v_lshlrev_b32 v150, 16, v132
    v_dot2_f32_bf16 v142, v32, v132, v142
    v_dot2_f32_bf16 v144, v33, v132, v144
    v_dot2_f32_bf16 v146, v34, v132, v146
    v_dot2_f32_bf16 v148, v35, v132, v148
    v_dot2_f32_bf16 v143, v32, v150, v143
    v_dot2_f32_bf16 v145, v33, v150, v145
    v_dot2_f32_bf16 v147, v34, v150, v147
    v_dot2_f32_bf16 v149, v35, v150, v149
    s_waitcnt vmcnt(22) lgkmcnt(8)
    v_lshlrev_b32 v150, 16, v133
    v_dot2_f32_bf16 v142, v36, v133, v142
    v_dot2_f32_bf16 v144, v37, v133, v144
    v_dot2_f32_bf16 v146, v38, v133, v146
    v_dot2_f32_bf16 v148, v39, v133, v148
    v_dot2_f32_bf16 v143, v36, v150, v143
    v_dot2_f32_bf16 v145, v37, v150, v145
    v_dot2_f32_bf16 v147, v38, v150, v147
    v_dot2_f32_bf16 v149, v39, v150, v149
    s_waitcnt vmcnt(21) lgkmcnt(7)
    v_lshlrev_b32 v150, 16, v134
    v_dot2_f32_bf16 v142, v40, v134, v142
    v_dot2_f32_bf16 v144, v41, v134, v144
    v_dot2_f32_bf16 v146, v42, v134, v146
    v_dot2_f32_bf16 v148, v43, v134, v148
    v_dot2_f32_bf16 v143, v40, v150, v143
    v_dot2_f32_bf16 v145, v41, v150, v145
    v_dot2_f32_bf16 v147, v42, v150, v147
    v_dot2_f32_bf16 v149, v43, v150, v149
    s_waitcnt vmcnt(20) lgkmcnt(6)
    v_lshlrev_b32 v150, 16, v135
    v_dot2_f32_bf16 v142, v44, v135, v142
    v_dot2_f32_bf16 v144, v45, v135, v144
    v_dot2_f32_bf16 v146, v46, v135, v146
    v_dot2_f32_bf16 v148, v47, v135, v148
    v_dot2_f32_bf16 v143, v44, v150, v143
    v_dot2_f32_bf16 v145, v45, v150, v145
    v_dot2_f32_bf16 v147, v46, v150, v147
    v_dot2_f32_bf16 v149, v47, v150, v149
    s_waitcnt vmcnt(19) lgkmcnt(5)
    v_lshlrev_b32 v150, 16, v136
    v_dot2_f32_bf16 v142, v48, v136, v142
    v_dot2_f32_bf16 v144, v49, v136, v144
    v_dot2_f32_bf16 v146, v50, v136, v146
    v_dot2_f32_bf16 v148, v51, v136, v148
    v_dot2_f32_bf16 v143, v48, v150, v143
    v_dot2_f32_bf16 v145, v49, v150, v145
    v_dot2_f32_bf16 v147, v50, v150, v147
    v_dot2_f32_bf16 v149, v51, v150, v149
    s_waitcnt vmcnt(18) lgkmcnt(4)
    v_lshlrev_b32 v150, 16, v137
    v_dot2_f32_bf16 v142, v52, v137, v142
    v_dot2_f32_bf16 v144, v53, v137, v144
    v_dot2_f32_bf16 v146, v54, v137, v146
    v_dot2_f32_bf16 v148, v55, v137, v148
    v_dot2_f32_bf16 v143, v52, v150, v143
    v_dot2_f32_bf16 v145, v53, v150, v145
    v_dot2_f32_bf16 v147, v54, v150, v147
    v_dot2_f32_bf16 v149, v55, v150, v149
    s_waitcnt vmcnt(17) lgkmcnt(3)
    v_lshlrev_b32 v150, 16, v138
    v_dot2_f32_bf16 v142, v56, v138, v142
    v_dot2_f32_bf16 v144, v57, v138, v144
    v_dot2_f32_bf16 v146, v58, v138, v146
    v_dot2_f32_bf16 v148, v59, v138, v148
    v_dot2_f32_bf16 v143, v56, v150, v143
    v_dot2_f32_bf16 v145, v57, v150, v145
    v_dot2_f32_bf16 v147, v58, v150, v147
    v_dot2_f32_bf16 v149, v59, v150, v149
    s_waitcnt vmcnt(16) lgkmcnt(2)
    v_lshlrev_b32 v150, 16, v139
    v_dot2_f32_bf16 v142, v60, v139, v142
    v_dot2_f32_bf16 v144, v61, v139, v144
    v_dot2_f32_bf16 v146, v62, v139, v146
    v_dot2_f32_bf16 v148, v63, v139, v148
    v_dot2_f32_bf16 v143, v60, v150, v143
    v_dot2_f32_bf16 v145, v61, v150, v145
    v_dot2_f32_bf16 v147, v62, v150, v147
    v_dot2_f32_bf16 v149, v63, v150, v149
    s_waitcnt vmcnt(15) lgkmcnt(1)
    v_lshlrev_b32 v150, 16, v140
    v_dot2_f32_bf16 v142, v64, v140, v142
    v_dot2_f32_bf16 v144, v65, v140, v144
    v_dot2_f32_bf16 v146, v66, v140, v146
    v_dot2_f32_bf16 v148, v67, v140, v148
    v_dot2_f32_bf16 v143, v64, v150, v143
    v_dot2_f32_bf16 v145, v65, v150, v145
    v_dot2_f32_bf16 v147, v66, v150, v147
    v_dot2_f32_bf16 v149, v67, v150, v149
    s_waitcnt vmcnt(14) lgkmcnt(0)
    v_lshlrev_b32 v150, 16, v141
    v_dot2_f32_bf16 v142, v68, v141, v142
    v_dot2_f32_bf16 v144, v69, v141, v144
    v_dot2_f32_bf16 v146, v70, v141, v146
    v_dot2_f32_bf16 v148, v71, v141, v148
    v_dot2_f32_bf16 v143, v68, v150, v143
    v_dot2_f32_bf16 v145, v69, v150, v145
    v_dot2_f32_bf16 v147, v70, v150, v147
    v_dot2_f32_bf16 v149, v71, v150, v149
    v_permlane32_swap_b32 v142, v146
    s_nop 0
    v_permlane32_swap_b32 v143, v147
    v_permlane32_swap_b32 v144, v148
    v_permlane32_swap_b32 v145, v149
    v_pk_add_f32 v[142:143], v[142:143], v[146:147]
    v_pk_add_f32 v[144:145], v[144:145], v[148:149]
    s_nop 1
    v_permlane16_swap_b32 v142, v144
    v_permlane16_swap_b32 v143, v145
    v_pk_add_f32 v[142:143], v[142:143], v[144:145]
    s_nop 1
    v_add_f32_dpp v144, v142, v142 row_ror:8 row_mask:0xf bank_mask:0xf
    s_nop 1
    v_add_f32_dpp v144, v143, v143 row_ror:8 row_mask:0xf bank_mask:0xc
    ds_write_b32 v9, v144 offset:0
    s_load_dword s75, s[28:29], 0x0
    s_lshr_b32 s36, s32, 1
    s_lshl_b32 s6, s33, 2
    s_add_u32 s36, s36, s6
    s_and_b32 s6, s32, 1
    s_mul_i32 s6, s6, 14
    s_add_u32 s37, s6, s36
    s_cmp_eq_u32 s42, 0
    s_cselect_b32 s48, s16, s18
    s_cselect_b32 s49, s17, s19
    s_and_b32 s49, s49, 0xffff
    s_cmp_lt_u32 s36, 14
    s_cselect_b32 s50, 1605632, 0
    s_mov_b32 s51, 0x20000
    v_bfe_u32 v150, v2, 4, 1
    v_lshlrev_b32 v150, 2, v150
    v_xor_b32 v150, v150, v8
    v_mul_u32_u24 v15, 3584, v6
    v_lshl_add_u32 v15, v150, 4, v15
    s_mul_i32 s54, s43, 802816
    s_lshl_b32 s6, s37, 7
    s_add_u32 s54, s54, s6
    s_mul_i32 s55, s42, 57344
    s_mul_i32 s6, s43, 28672
    s_add_u32 s56, s55, s6
    s_add_u32 m0, s56, 24576
    s_add_u32 s54, s54, 458752
    s_cmp_eq_u32 s43, 0
    s_cselect_b32 s64, 1, -1
    s_cselect_b32 s66, -27, s64
    s_cselect_b32 s68, s64, 27
    s_mul_i32 s65, s64, 28672
    s_mul_i32 s67, s66, 28672
    s_mul_i32 s69, s68, 28672
    s_lshl_b32 s64, s64, 10
    s_lshl_b32 s66, s66, 10
    s_lshl_b32 s68, s68, 10
    s_lshl_b32 s58, s32, 7
    s_lshl_b32 s6, s3, 12
    s_add_u32 s58, s58, s6
    s_add_u32 s24, s30, 2260992
    s_addc_u32 s25, s31, 0
    s_mov_b32 s74, 1
    v_mov_b64 v[142:143], 0
    v_mov_b64 v[144:145], 0
    v_mov_b64 v[146:147], 0
    v_mov_b64 v[148:149], 0
    s_waitcnt vmcnt(13)
    v_lshlrev_b32 v150, 16, v128
    v_dot2_f32_bf16 v142, v72, v128, v142
    v_dot2_f32_bf16 v144, v73, v128, v144
    v_dot2_f32_bf16 v146, v74, v128, v146
    v_dot2_f32_bf16 v148, v75, v128, v148
    v_dot2_f32_bf16 v143, v72, v150, v143
    v_dot2_f32_bf16 v145, v73, v150, v145
    v_dot2_f32_bf16 v147, v74, v150, v147
    v_dot2_f32_bf16 v149, v75, v150, v149
    s_waitcnt vmcnt(12)
    v_lshlrev_b32 v150, 16, v129
    v_dot2_f32_bf16 v142, v76, v129, v142
    v_dot2_f32_bf16 v144, v77, v129, v144
    v_dot2_f32_bf16 v146, v78, v129, v146
    v_dot2_f32_bf16 v148, v79, v129, v148
    v_dot2_f32_bf16 v143, v76, v150, v143
    v_dot2_f32_bf16 v145, v77, v150, v145
    v_dot2_f32_bf16 v147, v78, v150, v147
    v_dot2_f32_bf16 v149, v79, v150, v149
    s_waitcnt vmcnt(11)
    v_lshlrev_b32 v150, 16, v130
    v_dot2_f32_bf16 v142, v80, v130, v142
    v_dot2_f32_bf16 v144, v81, v130, v144
    v_dot2_f32_bf16 v146, v82, v130, v146
    v_dot2_f32_bf16 v148, v83, v130, v148
    v_dot2_f32_bf16 v143, v80, v150, v143
    v_dot2_f32_bf16 v145, v81, v150, v145
    v_dot2_f32_bf16 v147, v82, v150, v147
    v_dot2_f32_bf16 v149, v83, v150, v149
    s_waitcnt vmcnt(10)
    v_lshlrev_b32 v150, 16, v131
    v_dot2_f32_bf16 v142, v84, v131, v142
    v_dot2_f32_bf16 v144, v85, v131, v144
    v_dot2_f32_bf16 v146, v86, v131, v146
    v_dot2_f32_bf16 v148, v87, v131, v148
    v_dot2_f32_bf16 v143, v84, v150, v143
    v_dot2_f32_bf16 v145, v85, v150, v145
    v_dot2_f32_bf16 v147, v86, v150, v147
    v_dot2_f32_bf16 v149, v87, v150, v149
    s_waitcnt vmcnt(9)
    v_lshlrev_b32 v150, 16, v132
    v_dot2_f32_bf16 v142, v88, v132, v142
    v_dot2_f32_bf16 v144, v89, v132, v144
    v_dot2_f32_bf16 v146, v90, v132, v146
    v_dot2_f32_bf16 v148, v91, v132, v148
    v_dot2_f32_bf16 v143, v88, v150, v143
    v_dot2_f32_bf16 v145, v89, v150, v145
    v_dot2_f32_bf16 v147, v90, v150, v147
    v_dot2_f32_bf16 v149, v91, v150, v149
    s_waitcnt vmcnt(8)
    v_lshlrev_b32 v150, 16, v133
    v_dot2_f32_bf16 v142, v92, v133, v142
    v_dot2_f32_bf16 v144, v93, v133, v144
    v_dot2_f32_bf16 v146, v94, v133, v146
    v_dot2_f32_bf16 v148, v95, v133, v148
    v_dot2_f32_bf16 v143, v92, v150, v143
    v_dot2_f32_bf16 v145, v93, v150, v145
    v_dot2_f32_bf16 v147, v94, v150, v147
    v_dot2_f32_bf16 v149, v95, v150, v149
    s_waitcnt vmcnt(7)
    v_lshlrev_b32 v150, 16, v134
    v_dot2_f32_bf16 v142, v96, v134, v142
    v_dot2_f32_bf16 v144, v97, v134, v144
    v_dot2_f32_bf16 v146, v98, v134, v146
    v_dot2_f32_bf16 v148, v99, v134, v148
    v_dot2_f32_bf16 v143, v96, v150, v143
    v_dot2_f32_bf16 v145, v97, v150, v145
    v_dot2_f32_bf16 v147, v98, v150, v147
    v_dot2_f32_bf16 v149, v99, v150, v149
    s_waitcnt vmcnt(6)
    v_lshlrev_b32 v150, 16, v135
    v_dot2_f32_bf16 v142, v100, v135, v142
    v_dot2_f32_bf16 v144, v101, v135, v144
    v_dot2_f32_bf16 v146, v102, v135, v146
    v_dot2_f32_bf16 v148, v103, v135, v148
    v_dot2_f32_bf16 v143, v100, v150, v143
    v_dot2_f32_bf16 v145, v101, v150, v145
    v_dot2_f32_bf16 v147, v102, v150, v147
    v_dot2_f32_bf16 v149, v103, v150, v149
    s_waitcnt vmcnt(5)
    v_lshlrev_b32 v150, 16, v136
    v_dot2_f32_bf16 v142, v104, v136, v142
    v_dot2_f32_bf16 v144, v105, v136, v144
    v_dot2_f32_bf16 v146, v106, v136, v146
    v_dot2_f32_bf16 v148, v107, v136, v148
    v_dot2_f32_bf16 v143, v104, v150, v143
    v_dot2_f32_bf16 v145, v105, v150, v145
    v_dot2_f32_bf16 v147, v106, v150, v147
    v_dot2_f32_bf16 v149, v107, v150, v149
    s_waitcnt vmcnt(4)
    v_lshlrev_b32 v150, 16, v137
    v_dot2_f32_bf16 v142, v108, v137, v142
    v_dot2_f32_bf16 v144, v109, v137, v144
    v_dot2_f32_bf16 v146, v110, v137, v146
    v_dot2_f32_bf16 v148, v111, v137, v148
    v_dot2_f32_bf16 v143, v108, v150, v143
    v_dot2_f32_bf16 v145, v109, v150, v145
    v_dot2_f32_bf16 v147, v110, v150, v147
    v_dot2_f32_bf16 v149, v111, v150, v149
    s_waitcnt vmcnt(3)
    v_lshlrev_b32 v150, 16, v138
    v_dot2_f32_bf16 v142, v112, v138, v142
    v_dot2_f32_bf16 v144, v113, v138, v144
    v_dot2_f32_bf16 v146, v114, v138, v146
    v_dot2_f32_bf16 v148, v115, v138, v148
    v_dot2_f32_bf16 v143, v112, v150, v143
    v_dot2_f32_bf16 v145, v113, v150, v145
    v_dot2_f32_bf16 v147, v114, v150, v147
    v_dot2_f32_bf16 v149, v115, v150, v149
    s_waitcnt vmcnt(2)
    v_lshlrev_b32 v150, 16, v139
    v_dot2_f32_bf16 v142, v116, v139, v142
    v_dot2_f32_bf16 v144, v117, v139, v144
    v_dot2_f32_bf16 v146, v118, v139, v146
    v_dot2_f32_bf16 v148, v119, v139, v148
    v_dot2_f32_bf16 v143, v116, v150, v143
    v_dot2_f32_bf16 v145, v117, v150, v145
    v_dot2_f32_bf16 v147, v118, v150, v147
    v_dot2_f32_bf16 v149, v119, v150, v149
    s_waitcnt vmcnt(1)
    v_lshlrev_b32 v150, 16, v140
    v_dot2_f32_bf16 v142, v120, v140, v142
    v_dot2_f32_bf16 v144, v121, v140, v144
    v_dot2_f32_bf16 v146, v122, v140, v146
    v_dot2_f32_bf16 v148, v123, v140, v148
    v_dot2_f32_bf16 v143, v120, v150, v143
    v_dot2_f32_bf16 v145, v121, v150, v145
    v_dot2_f32_bf16 v147, v122, v150, v147
    v_dot2_f32_bf16 v149, v123, v150, v149
    s_waitcnt vmcnt(0)
    v_lshlrev_b32 v150, 16, v141
    v_dot2_f32_bf16 v142, v124, v141, v142
    v_dot2_f32_bf16 v144, v125, v141, v144
    v_dot2_f32_bf16 v146, v126, v141, v146
    v_dot2_f32_bf16 v148, v127, v141, v148
    v_dot2_f32_bf16 v143, v124, v150, v143
    v_dot2_f32_bf16 v145, v125, v150, v145
    v_dot2_f32_bf16 v147, v126, v150, v147
    v_dot2_f32_bf16 v149, v127, v150, v149
    v_permlane32_swap_b32 v142, v146
    s_nop 0
    v_permlane32_swap_b32 v143, v147
    v_permlane32_swap_b32 v144, v148
    v_permlane32_swap_b32 v145, v149
    v_pk_add_f32 v[142:143], v[142:143], v[146:147]
    v_pk_add_f32 v[144:145], v[144:145], v[148:149]
    s_nop 1
    v_permlane16_swap_b32 v142, v144
    v_permlane16_swap_b32 v143, v145
    v_pk_add_f32 v[142:143], v[142:143], v[144:145]
    s_nop 1
    v_add_f32_dpp v144, v142, v142 row_ror:8 row_mask:0xf bank_mask:0xf
    s_nop 1
    v_add_f32_dpp v144, v143, v143 row_ror:8 row_mask:0xf bank_mask:0xc
    ds_write_b32 v9, v144 offset:1024
    s_waitcnt lgkmcnt(0)
    s_barrier
    s_cmp_lg_u32 s75, 0
    s_cbranch_scc1 BG_74
    s_mov_b32 s1, 0
    v_mov_b32 v242, 0
BS_73:
    s_sleep 8
    global_load_dword v243, v242, s[28:29] sc1
    s_add_u32 s1, s1, 1
    s_waitcnt vmcnt(0)
    v_readfirstlane_b32 s75, v243
    s_cmp_gt_u32 s1, 1048576
    s_cbranch_scc1 BG_74
    s_cmp_lg_u32 s75, 0
    s_cbranch_scc0 BS_73
BG_74:
    ds_read2st64_b32 v[142:143], v241 offset0:0 offset1:1
    ds_read2st64_b32 v[144:145], v241 offset0:2 offset1:3
    s_waitcnt lgkmcnt(0)
    v_pk_add_f32 v[142:143], v[142:143], v[144:145]
    v_add_f32 v142, v142, v143
    v_cvt_pk_bf16_f32 v142, v142, v142
    v_and_b32 v142, 0xffff0000, v142
    v_lshl_add_u32 v150, v2, 1, s57
    v_mov_b32 v151, s57
    ds_write_b16_d16_hi v150, v142 offset:4096
    ds_read2st64_b32 v[142:143], v241 offset0:4 offset1:5
    ds_read2st64_b32 v[144:145], v241 offset0:6 offset1:7
    s_waitcnt lgkmcnt(0)
    v_pk_add_f32 v[142:143], v[142:143], v[144:145]
    v_add_f32 v142, v142, v143
    v_cvt_pk_bf16_f32 v142, v142, v142
    v_and_b32 v142, 0xffff0000, v142
    s_cmp_eq_u32 s33, 3
    s_cselect_b32 s6, 0, -1
    v_and_b32 v142, s6, v142
    ds_write_b16_d16_hi v150, v142 offset:4224
    ds_read_b128 v[16:19], v151 offset:4096
    ds_read_b128 v[20:23], v151 offset:4112
    ds_read_b128 v[24:27], v151 offset:4128
    ds_read_b128 v[28:31], v151 offset:4144
    ds_read_b128 v[32:35], v151 offset:4160
    ds_read_b128 v[36:39], v151 offset:4176
    ds_read_b128 v[40:43], v151 offset:4192
    ds_read_b128 v[44:47], v151 offset:4208
    ds_read_b128 v[48:51], v151 offset:4224
    ds_read_b128 v[52:55], v151 offset:4240
    ds_read_b128 v[56:59], v151 offset:4256
    ds_read_b128 v[60:63], v151 offset:4272
    ds_read_b128 v[64:67], v151 offset:4288
    ds_read_b128 v[68:71], v151 offset:4304
    ds_read_b128 v[72:75], v151 offset:4320
    ds_read_b128 v[76:79], v151 offset:4336
    v_mov_b64 v[144:145], 0
    v_mov_b64 v[146:147], 0
    s_lshl_b32 s6, s33, 10
    s_add_u32 s6, s6, 2244608
    v_lshlrev_b32 v150, 2, v0
    v_cmp_ge_u32 vcc, 224, v0
    v_mov_b32 v152, 0x7fff0000
    v_add_u32 v151, 896, v150
    v_cndmask_b32 v150, v152, v150, vcc
    v_subrev_u32 v153, 1, v0
    v_cmp_gt_u32 vcc, 31, v153
    s_nop 1
    v_cndmask_b32 v151, v152, v151, vcc
    s_waitcnt lgkmcnt(15)
    v_dot2_f32_bf16 v144, v176, v16, v144
    v_dot2_f32_bf16 v145, v177, v17, v145
    v_dot2_f32_bf16 v146, v178, v18, v146
    v_dot2_f32_bf16 v147, v179, v19, v147
    s_waitcnt lgkmcnt(14)
    v_dot2_f32_bf16 v144, v180, v20, v144
    v_dot2_f32_bf16 v145, v181, v21, v145
    v_dot2_f32_bf16 v146, v182, v22, v146
    v_dot2_f32_bf16 v147, v183, v23, v147
    s_waitcnt lgkmcnt(13)
    v_dot2_f32_bf16 v144, v184, v24, v144
    v_dot2_f32_bf16 v145, v185, v25, v145
    v_dot2_f32_bf16 v146, v186, v26, v146
    v_dot2_f32_bf16 v147, v187, v27, v147
    s_waitcnt lgkmcnt(12)
    v_dot2_f32_bf16 v144, v188, v28, v144
    v_dot2_f32_bf16 v145, v189, v29, v145
    v_dot2_f32_bf16 v146, v190, v30, v146
    v_dot2_f32_bf16 v147, v191, v31, v147
    s_waitcnt lgkmcnt(11)
    v_dot2_f32_bf16 v144, v192, v32, v144
    v_dot2_f32_bf16 v145, v193, v33, v145
    v_dot2_f32_bf16 v146, v194, v34, v146
    v_dot2_f32_bf16 v147, v195, v35, v147
    s_waitcnt lgkmcnt(10)
    v_dot2_f32_bf16 v144, v196, v36, v144
    v_dot2_f32_bf16 v145, v197, v37, v145
    v_dot2_f32_bf16 v146, v198, v38, v146
    v_dot2_f32_bf16 v147, v199, v39, v147
    s_waitcnt lgkmcnt(9)
    v_dot2_f32_bf16 v144, v200, v40, v144
    v_dot2_f32_bf16 v145, v201, v41, v145
    v_dot2_f32_bf16 v146, v202, v42, v146
    v_dot2_f32_bf16 v147, v203, v43, v147
    s_waitcnt lgkmcnt(8)
    v_dot2_f32_bf16 v144, v204, v44, v144
    v_dot2_f32_bf16 v145, v205, v45, v145
    v_dot2_f32_bf16 v146, v206, v46, v146
    v_dot2_f32_bf16 v147, v207, v47, v147
    s_waitcnt lgkmcnt(7)
    v_dot2_f32_bf16 v144, v208, v48, v144
    v_dot2_f32_bf16 v145, v209, v49, v145
    v_dot2_f32_bf16 v146, v210, v50, v146
    v_dot2_f32_bf16 v147, v211, v51, v147
    s_waitcnt lgkmcnt(6)
    v_dot2_f32_bf16 v144, v212, v52, v144
    v_dot2_f32_bf16 v145, v213, v53, v145
    v_dot2_f32_bf16 v146, v214, v54, v146
    v_dot2_f32_bf16 v147, v215, v55, v147
    s_waitcnt lgkmcnt(5)
    v_dot2_f32_bf16 v144, v216, v56, v144
    v_dot2_f32_bf16 v145, v217, v57, v145
    v_dot2_f32_bf16 v146, v218, v58, v146
    v_dot2_f32_bf16 v147, v219, v59, v147
    s_waitcnt lgkmcnt(4)
    v_dot2_f32_bf16 v144, v220, v60, v144
    v_dot2_f32_bf16 v145, v221, v61, v145
    v_dot2_f32_bf16 v146, v222, v62, v146
    v_dot2_f32_bf16 v147, v223, v63, v147
    s_waitcnt lgkmcnt(3)
    v_dot2_f32_bf16 v144, v224, v64, v144
    v_dot2_f32_bf16 v145, v225, v65, v145
    v_dot2_f32_bf16 v146, v226, v66, v146
    v_dot2_f32_bf16 v147, v227, v67, v147
    s_waitcnt lgkmcnt(2)
    v_dot2_f32_bf16 v144, v228, v68, v144
    v_dot2_f32_bf16 v145, v229, v69, v145
    v_dot2_f32_bf16 v146, v230, v70, v146
    v_dot2_f32_bf16 v147, v231, v71, v147
    s_waitcnt lgkmcnt(1)
    v_dot2_f32_bf16 v144, v232, v72, v144
    v_dot2_f32_bf16 v145, v233, v73, v145
    v_dot2_f32_bf16 v146, v234, v74, v146
    v_dot2_f32_bf16 v147, v235, v75, v147
    s_waitcnt lgkmcnt(0)
    v_dot2_f32_bf16 v144, v236, v76, v144
    v_dot2_f32_bf16 v145, v237, v77, v145
    v_dot2_f32_bf16 v146, v238, v78, v146
    v_dot2_f32_bf16 v147, v239, v79, v147
    s_nop 2
    v_pk_add_f32 v[144:145], v[144:145], v[146:147]
    v_add_f32 v144, v144, v145
    v_cvt_pk_bf16_f32 v145, v144, v144
    v_and_b32 v145, 0xffff0000, v145
    v_sub_f32 v145, v144, v145
    v_cvt_pk_bf16_f32 v144, v144, v145
    buffer_store_dword v144, v150, s[12:15], s6 offen sc1
    buffer_store_dword v144, v151, s[12:15], s6 offen sc1
    s_waitcnt vmcnt(0)
    s_barrier
    s_cmp_lg_u32 s3, 0
    s_cbranch_scc1 SIG_75
    s_mov_b32 s74, 1
    s_atomic_add s74, s[24:25], 22400
SIG_75:
    s_branch SD_G3
KP_END:
    s_endpgm
KP_LAST:
.section .rodata,"a"
.p2align 6
.amdhsa_kernel adaLN_cond__spectral_fnet__glu_gated_glu__prompt_kernel
  .amdhsa_next_free_vgpr 512
  .amdhsa_next_free_sgpr 102
  .amdhsa_accum_offset 256
  .amdhsa_group_segment_fixed_size 0
  .amdhsa_kernarg_size 112
  .amdhsa_user_sgpr_count 2
  .amdhsa_user_sgpr_kernarg_segment_ptr 1
  .amdhsa_system_sgpr_workgroup_id_x 1
  .amdhsa_float_denorm_mode_32 3
.end_amdhsa_kernel
```
